```python
import torch

def _softmax(x, axis=-1):
    return torch.softmax(x, dim=axis)

def _gelu(x):
    return torch.nn.functional.gelu(x, approximate='tanh')

def _silu(x):
    return torch.nn.functional.silu(x)

def _sigmoid(x):
    return torch.sigmoid(x)

def _layernorm(x, axis=-1, eps=1e-05):
    m = x.mean(dim=axis, keepdim=True)
    v = x.var(dim=axis, keepdim=True, unbiased=False)
    return (x - m) / torch.sqrt(v + eps)

def _scatter_add(tgt, idx, src, axis=0):
    return tgt.clone().index_add_(axis, idx, src)

def _segment_sum(src, seg, n):
    out = torch.zeros((n,) + src.shape[1:], dtype=src.dtype)
    return out.index_add_(0, seg, src)

def _pad(x, pw):
    flat = tuple((v for pair in reversed(pw) for v in pair))
    return torch.nn.functional.pad(x, flat)
kernel_name = 'standalone__kv_cache_quant_pre_rope_vs_post_rope__prompt'

def setup_inputs():

    _w = lambda a: (lambda t: t.to(torch.bfloat16) if t.is_floating_point() else t)(torch.as_tensor(a))
    B, Sq, Skv = (1, 2048, 2048)
    H, Dh0 = (16, 128)
    G = -1 if -1 > 0 else Dh0
    G = max(2, G // 2 * 2)
    Dh = max(G, Dh0 // G * G)
    Skv = max(Skv, Sq)
    ng = Dh // G
    bits = 3 if 3 > 1 else 4
    bits = max(2, min(8, bits))
    qmax = (1 << bits) - 1
    half = Dh // 2
    inv = 1.0 / 10000.0 ** (torch.arange(half) / max(1, half))
    ang_k = torch.arange(Skv)[:, None] * inv[None, :]
    ang_q = torch.arange(Skv - Sq, Skv)[:, None] * inv[None, :]
    kc = torch.cat([torch.cos(ang_k), torch.cos(ang_k)], dim=-1)
    ks = torch.cat([torch.sin(ang_k), torch.sin(ang_k)], dim=-1)
    qc = torch.cat([torch.cos(ang_q), torch.cos(ang_q)], dim=-1)
    qs = torch.cat([torch.sin(ang_q), torch.sin(ang_q)], dim=-1)
    qk_i = torch.randint(0, qmax + 1, (B, H, Skv, Dh)).to(torch.int32)
    qv_i = torch.randint(0, qmax + 1, (B, H, Skv, Dh)).to(torch.int32)
    ksc = torch.abs((lambda *s: torch.randn(*s, dtype=torch.bfloat16) * 0.4)(B, H, Skv, ng)) * 0.1 + 0.01
    kzp = torch.full((B, H, Skv, ng), qmax / 2.0)
    vsc = torch.abs((lambda *s: torch.randn(*s, dtype=torch.bfloat16) * 0.4)(B, H, Skv, ng)) * 0.1 + 0.01
    vzp = torch.full((B, H, Skv, ng), qmax / 2.0)
    return {'q': _w((lambda *s: torch.randn(*s, dtype=torch.bfloat16) * 6.4)(B, H, Sq, Dh) * 0.5), 'qk': _w(qk_i), 'k_scales': _w(ksc), 'k_zeros': _w(kzp), 'qv': _w(qv_i), 'v_scales': _w(vsc), 'v_zeros': _w(vzp), 'q_cos': _w(qc), 'q_sin': _w(qs), 'k_cos': _w(kc), 'k_sin': _w(ks)}

def reference(q, qk, k_scales, k_zeros, qv, v_scales, v_zeros, q_cos, q_sin, k_cos, k_sin):
    B, H, Sq, Dh = q.shape
    ng = k_scales.shape[-1]
    G = Dh // ng
    half = Dh // 2
    ks = (lambda x, n, axis: torch.repeat_interleave(x, n, dim=axis))(k_scales, G, axis=-1)
    kz = (lambda x, n, axis: torch.repeat_interleave(x, n, dim=axis))(k_zeros, G, axis=-1)
    k = ((lambda x, dt: x.to(dt))(qk, q.dtype) - kz) * ks
    vs = (lambda x, n, axis: torch.repeat_interleave(x, n, dim=axis))(v_scales, G, axis=-1)
    vz = (lambda x, n, axis: torch.repeat_interleave(x, n, dim=axis))(v_zeros, G, axis=-1)
    v = ((lambda x, dt: x.to(dt))(qv, q.dtype) - vz) * vs
    k1 = k[..., :half].clone()
    k2 = k[..., half:].clone()
    krh = torch.concatenate([-k2, k1], axis=-1)
    kr = k * k_cos[None, None, :, :] + krh * k_sin[None, None, :, :]
    q1 = q[..., :half].clone()
    q2 = q[..., half:].clone()
    qrh = torch.concatenate([-q2, q1], axis=-1)
    qr = q * q_cos[None, None, :, :] + qrh * q_sin[None, None, :, :]
    logits = torch.einsum('bhqd,bhkd->bhqk', qr, kr) * float(Dh) ** (-0.5)
    attn = _softmax(logits, axis=-1)
    out = torch.einsum('bhqk,bhkd->bhqd', attn, v)
    return out
```

```asm
; @launch grid=(256,1,1) block=(512,1,1) lds=131136
.amdgcn_target "amdgcn-amd-amdhsa--gfx950"
.text
.globl standalone__kv_cache_quant_pre_rope_vs_post_rope__prompt_kernel
.p2align 8
.type standalone__kv_cache_quant_pre_rope_vs_post_rope__prompt_kernel,@function
standalone__kv_cache_quant_pre_rope_vs_post_rope__prompt_kernel:
    s_cmp_ge_u32 s2, 256
    s_cbranch_scc1 standalone__kv_cache_quant_pre_rope_vs_post_rope__prompt_kernel_end
    s_load_dwordx16 s[44:59], s[0:1], 0
    s_load_dwordx8 s[60:67], s[0:1], 64
    s_load_dwordx4 s[68:71], s[0:1], 96
    v_lshrrev_b32 v1, 6, v0
    v_and_b32 v2, 63, v0
    s_nop 0
    v_readfirstlane_b32 s20, v1
    s_and_b32 s21, s2, 7
    s_lshr_b32 s22, s2, 7
    s_lshl_b32 s22, s22, 3
    s_add_u32 s21, s21, s22
    s_lshr_b32 s22, s2, 3
    s_and_b32 s22, s22, 15
    s_lshl_b32 s23, s21, 20
    s_lshl_b32 s41, s21, 2
    s_waitcnt lgkmcnt(0)
    s_add_u32 s24, s70, s23
    s_addc_u32 s25, s71, 0
    s_mov_b32 s26, 0x100000
    s_mov_b32 s27, 0x20000
    s_lshl_b32 s42, s21, 8
    s_add_u32 s42, s42, 0x1000000
    s_add_u32 s72, s70, s42
    s_addc_u32 s73, s71, 0
    s_mov_b32 s74, 0x100
    s_mov_b32 s75, 0x20000
    s_mov_b32 s19, 0
    s_cmp_ge_u32 s20, 4
    s_cbranch_scc1 standalone__kv_cache_quant_pre_rope_vs_post_rope__prompt_kernel_helper
    s_setprio 3
    s_lshl_b32 s28, s22, 15
    s_lshl_b32 s29, s20, 13
    s_add_u32 s28, s28, s29
    s_lshl_b32 s29, s21, 19
    s_add_u32 s29, s29, s28
    s_add_u32 s32, s44, s29
    s_addc_u32 s33, s45, 0
    s_mov_b32 s34, 0x2000
    s_mov_b32 s35, 0x20000
    s_add_u32 s36, s58, s28
    s_addc_u32 s37, s59, 0
    s_mov_b32 s38, 0x2000
    s_mov_b32 s39, 0x20000
    s_add_u32 s76, s60, s28
    s_addc_u32 s77, s61, 0
    s_mov_b32 s78, 0x2000
    s_mov_b32 s79, 0x20000
    s_add_u32 s80, s66, s29
    s_addc_u32 s81, s67, 0
    s_mov_b32 s82, 0x2000
    s_mov_b32 s83, 0x20000
    v_and_b32 v3, 15, v2
    v_lshrrev_b32 v4, 4, v2
    v_lshlrev_b32 v198, 8, v3
    v_lshl_add_u32 v198, v4, 4, v198
    v_lshlrev_b32 v199, 4, v2
    v_add_u32 v204, 0x1000, v198
    v_lshlrev_b32 v205, 8, v3
    v_lshl_add_u32 v205, v4, 5, v205
    v_add_u32 v206, 0x1000, v205
    v_and_b32 v207, 3, v2
    v_cmp_eq_u32 vcc, 0, v207
    v_mov_b32 v192, 0
    v_mov_b32 v193, 0x3f803f80
    v_cndmask_b32 v192, v192, v193, vcc
    v_mov_b32 v193, v192
    v_mov_b32 v194, v192
    v_mov_b32 v195, v192
    v_lshrrev_b32 v5, 3, v2
    v_and_b32 v6, 7, v2
    v_lshlrev_b32 v200, 8, v5
    v_lshl_add_u32 v200, v6, 4, v200
    v_add_u32 v201, 0x1000, v200
    s_lshl_b32 s29, s20, 13
    s_add_u32 s29, s29, 0x18000
    v_xor_b32 v7, v5, v6
    v_lshlrev_b32 v7, 4, v7
    v_lshl_add_u32 v176, v5, 8, v7
    v_add_u32 v176, s29, v176
    v_xor_b32 v177, 0x80, v176
    v_xor_b32 v7, v3, v4
    v_lshlrev_b32 v7, 4, v7
    v_lshl_add_u32 v178, v3, 8, v7
    v_add_u32 v178, s29, v178
    v_xor_b32 v179, 0x40, v178
    v_xor_b32 v180, 0x80, v178
    v_xor_b32 v181, 0xc0, v178
    s_barrier
    s_barrier
    buffer_load_dwordx4 v[0:3], v200, s[32:35], 0 offen offset:0 nt
    buffer_load_dwordx4 v[4:7], v200, s[32:35], 0 offen offset:128 nt
    buffer_load_dwordx4 v[32:35], v200, s[36:39], 0 offen offset:0
    buffer_load_dwordx4 v[36:39], v200, s[36:39], 0 offen offset:128
    buffer_load_dwordx4 v[96:99], v200, s[76:79], 0 offen offset:0
    buffer_load_dwordx4 v[100:103], v200, s[76:79], 0 offen offset:128
    buffer_load_dwordx4 v[8:11], v200, s[32:35], 0 offen offset:2048 nt
    buffer_load_dwordx4 v[12:15], v200, s[32:35], 0 offen offset:2176 nt
    buffer_load_dwordx4 v[40:43], v200, s[36:39], 0 offen offset:2048
    buffer_load_dwordx4 v[44:47], v200, s[36:39], 0 offen offset:2176
    buffer_load_dwordx4 v[104:107], v200, s[76:79], 0 offen offset:2048
    buffer_load_dwordx4 v[108:111], v200, s[76:79], 0 offen offset:2176
    buffer_load_dwordx4 v[16:19], v201, s[32:35], 0 offen offset:0 nt
    buffer_load_dwordx4 v[20:23], v201, s[32:35], 0 offen offset:128 nt
    buffer_load_dwordx4 v[48:51], v201, s[36:39], 0 offen offset:0
    buffer_load_dwordx4 v[52:55], v201, s[36:39], 0 offen offset:128
    buffer_load_dwordx4 v[112:115], v201, s[76:79], 0 offen offset:0
    buffer_load_dwordx4 v[116:119], v201, s[76:79], 0 offen offset:128
    buffer_load_dwordx4 v[24:27], v201, s[32:35], 0 offen offset:2048 nt
    buffer_load_dwordx4 v[28:31], v201, s[32:35], 0 offen offset:2176 nt
    buffer_load_dwordx4 v[56:59], v201, s[36:39], 0 offen offset:2048
    buffer_load_dwordx4 v[60:63], v201, s[36:39], 0 offen offset:2176
    buffer_load_dwordx4 v[120:123], v201, s[76:79], 0 offen offset:2048
    buffer_load_dwordx4 v[124:127], v201, s[76:79], 0 offen offset:2176
    v_mov_b32 v202, 0
    v_mov_b32 v203, 131072
    ds_write_b32 v203, v202
    s_waitcnt vmcnt(18)
    v_lshlrev_b32 v128, 16, v0
    v_lshlrev_b32 v129, 16, v4
    v_lshlrev_b32 v130, 16, v32
    v_lshlrev_b32 v131, 16, v36
    v_lshlrev_b32 v132, 16, v96
    v_lshlrev_b32 v133, 16, v100
    v_mul_f32 v132, v129, v132
    v_mul_f32 v133, v128, v133
    v_fma_f32 v134, v128, v130, -v132
    v_fma_f32 v136, v129, v131, v133
    v_and_b32 v128, 0xffff0000, v0
    v_and_b32 v129, 0xffff0000, v4
    v_and_b32 v130, 0xffff0000, v32
    v_and_b32 v131, 0xffff0000, v36
    v_and_b32 v132, 0xffff0000, v96
    v_and_b32 v133, 0xffff0000, v100
    v_mul_f32 v132, v129, v132
    v_mul_f32 v133, v128, v133
    v_fma_f32 v135, v128, v130, -v132
    v_fma_f32 v137, v129, v131, v133
    v_cvt_pk_bf16_f32 v144, v134, v135
    v_cvt_pk_bf16_f32 v148, v136, v137
    v_lshlrev_b32 v128, 16, v1
    v_lshlrev_b32 v129, 16, v5
    v_lshlrev_b32 v130, 16, v33
    v_lshlrev_b32 v131, 16, v37
    v_lshlrev_b32 v132, 16, v97
    v_lshlrev_b32 v133, 16, v101
    v_mul_f32 v132, v129, v132
    v_mul_f32 v133, v128, v133
    v_fma_f32 v134, v128, v130, -v132
    v_fma_f32 v136, v129, v131, v133
    v_and_b32 v128, 0xffff0000, v1
    v_and_b32 v129, 0xffff0000, v5
    v_and_b32 v130, 0xffff0000, v33
    v_and_b32 v131, 0xffff0000, v37
    v_and_b32 v132, 0xffff0000, v97
    v_and_b32 v133, 0xffff0000, v101
    v_mul_f32 v132, v129, v132
    v_mul_f32 v133, v128, v133
    v_fma_f32 v135, v128, v130, -v132
    v_fma_f32 v137, v129, v131, v133
    v_cvt_pk_bf16_f32 v145, v134, v135
    v_cvt_pk_bf16_f32 v149, v136, v137
    v_lshlrev_b32 v128, 16, v2
    v_lshlrev_b32 v129, 16, v6
    v_lshlrev_b32 v130, 16, v34
    v_lshlrev_b32 v131, 16, v38
    v_lshlrev_b32 v132, 16, v98
    v_lshlrev_b32 v133, 16, v102
    v_mul_f32 v132, v129, v132
    v_mul_f32 v133, v128, v133
    v_fma_f32 v134, v128, v130, -v132
    v_fma_f32 v136, v129, v131, v133
    v_and_b32 v128, 0xffff0000, v2
    v_and_b32 v129, 0xffff0000, v6
    v_and_b32 v130, 0xffff0000, v34
    v_and_b32 v131, 0xffff0000, v38
    v_and_b32 v132, 0xffff0000, v98
    v_and_b32 v133, 0xffff0000, v102
    v_mul_f32 v132, v129, v132
    v_mul_f32 v133, v128, v133
    v_fma_f32 v135, v128, v130, -v132
    v_fma_f32 v137, v129, v131, v133
    v_cvt_pk_bf16_f32 v146, v134, v135
    v_cvt_pk_bf16_f32 v150, v136, v137
    v_lshlrev_b32 v128, 16, v3
    v_lshlrev_b32 v129, 16, v7
    v_lshlrev_b32 v130, 16, v35
    v_lshlrev_b32 v131, 16, v39
    v_lshlrev_b32 v132, 16, v99
    v_lshlrev_b32 v133, 16, v103
    v_mul_f32 v132, v129, v132
    v_mul_f32 v133, v128, v133
    v_fma_f32 v134, v128, v130, -v132
    v_fma_f32 v136, v129, v131, v133
    v_and_b32 v128, 0xffff0000, v3
    v_and_b32 v129, 0xffff0000, v7
    v_and_b32 v130, 0xffff0000, v35
    v_and_b32 v131, 0xffff0000, v39
    v_and_b32 v132, 0xffff0000, v99
    v_and_b32 v133, 0xffff0000, v103
    v_mul_f32 v132, v129, v132
    v_mul_f32 v133, v128, v133
    v_fma_f32 v135, v128, v130, -v132
    v_fma_f32 v137, v129, v131, v133
    v_cvt_pk_bf16_f32 v147, v134, v135
    v_cvt_pk_bf16_f32 v151, v136, v137
    ds_write_b128 v176, v[144:147] offset:0
    ds_write_b128 v177, v[148:151] offset:0
    s_waitcnt vmcnt(12)
    v_lshlrev_b32 v128, 16, v8
    v_lshlrev_b32 v129, 16, v12
    v_lshlrev_b32 v130, 16, v40
    v_lshlrev_b32 v131, 16, v44
    v_lshlrev_b32 v132, 16, v104
    v_lshlrev_b32 v133, 16, v108
    v_mul_f32 v132, v129, v132
    v_mul_f32 v133, v128, v133
    v_fma_f32 v134, v128, v130, -v132
    v_fma_f32 v136, v129, v131, v133
    v_and_b32 v128, 0xffff0000, v8
    v_and_b32 v129, 0xffff0000, v12
    v_and_b32 v130, 0xffff0000, v40
    v_and_b32 v131, 0xffff0000, v44
    v_and_b32 v132, 0xffff0000, v104
    v_and_b32 v133, 0xffff0000, v108
    v_mul_f32 v132, v129, v132
    v_mul_f32 v133, v128, v133
    v_fma_f32 v135, v128, v130, -v132
    v_fma_f32 v137, v129, v131, v133
    v_cvt_pk_bf16_f32 v152, v134, v135
    v_cvt_pk_bf16_f32 v156, v136, v137
    v_lshlrev_b32 v128, 16, v9
    v_lshlrev_b32 v129, 16, v13
    v_lshlrev_b32 v130, 16, v41
    v_lshlrev_b32 v131, 16, v45
    v_lshlrev_b32 v132, 16, v105
    v_lshlrev_b32 v133, 16, v109
    v_mul_f32 v132, v129, v132
    v_mul_f32 v133, v128, v133
    v_fma_f32 v134, v128, v130, -v132
    v_fma_f32 v136, v129, v131, v133
    v_and_b32 v128, 0xffff0000, v9
    v_and_b32 v129, 0xffff0000, v13
    v_and_b32 v130, 0xffff0000, v41
    v_and_b32 v131, 0xffff0000, v45
    v_and_b32 v132, 0xffff0000, v105
    v_and_b32 v133, 0xffff0000, v109
    v_mul_f32 v132, v129, v132
    v_mul_f32 v133, v128, v133
    v_fma_f32 v135, v128, v130, -v132
    v_fma_f32 v137, v129, v131, v133
    v_cvt_pk_bf16_f32 v153, v134, v135
    v_cvt_pk_bf16_f32 v157, v136, v137
    v_lshlrev_b32 v128, 16, v10
    v_lshlrev_b32 v129, 16, v14
    v_lshlrev_b32 v130, 16, v42
    v_lshlrev_b32 v131, 16, v46
    v_lshlrev_b32 v132, 16, v106
    v_lshlrev_b32 v133, 16, v110
    v_mul_f32 v132, v129, v132
    v_mul_f32 v133, v128, v133
    v_fma_f32 v134, v128, v130, -v132
    v_fma_f32 v136, v129, v131, v133
    v_and_b32 v128, 0xffff0000, v10
    v_and_b32 v129, 0xffff0000, v14
    v_and_b32 v130, 0xffff0000, v42
    v_and_b32 v131, 0xffff0000, v46
    v_and_b32 v132, 0xffff0000, v106
    v_and_b32 v133, 0xffff0000, v110
    v_mul_f32 v132, v129, v132
    v_mul_f32 v133, v128, v133
    v_fma_f32 v135, v128, v130, -v132
    v_fma_f32 v137, v129, v131, v133
    v_cvt_pk_bf16_f32 v154, v134, v135
    v_cvt_pk_bf16_f32 v158, v136, v137
    v_lshlrev_b32 v128, 16, v11
    v_lshlrev_b32 v129, 16, v15
    v_lshlrev_b32 v130, 16, v43
    v_lshlrev_b32 v131, 16, v47
    v_lshlrev_b32 v132, 16, v107
    v_lshlrev_b32 v133, 16, v111
    v_mul_f32 v132, v129, v132
    v_mul_f32 v133, v128, v133
    v_fma_f32 v134, v128, v130, -v132
    v_fma_f32 v136, v129, v131, v133
    v_and_b32 v128, 0xffff0000, v11
    v_and_b32 v129, 0xffff0000, v15
    v_and_b32 v130, 0xffff0000, v43
    v_and_b32 v131, 0xffff0000, v47
    v_and_b32 v132, 0xffff0000, v107
    v_and_b32 v133, 0xffff0000, v111
    v_mul_f32 v132, v129, v132
    v_mul_f32 v133, v128, v133
    v_fma_f32 v135, v128, v130, -v132
    v_fma_f32 v137, v129, v131, v133
    v_cvt_pk_bf16_f32 v155, v134, v135
    v_cvt_pk_bf16_f32 v159, v136, v137
    ds_write_b128 v177, v[152:155] offset:2048
    ds_write_b128 v176, v[156:159] offset:2048
    s_waitcnt vmcnt(6)
    v_lshlrev_b32 v128, 16, v16
    v_lshlrev_b32 v129, 16, v20
    v_lshlrev_b32 v130, 16, v48
    v_lshlrev_b32 v131, 16, v52
    v_lshlrev_b32 v132, 16, v112
    v_lshlrev_b32 v133, 16, v116
    v_mul_f32 v132, v129, v132
    v_mul_f32 v133, v128, v133
    v_fma_f32 v134, v128, v130, -v132
    v_fma_f32 v136, v129, v131, v133
    v_and_b32 v128, 0xffff0000, v16
    v_and_b32 v129, 0xffff0000, v20
    v_and_b32 v130, 0xffff0000, v48
    v_and_b32 v131, 0xffff0000, v52
    v_and_b32 v132, 0xffff0000, v112
    v_and_b32 v133, 0xffff0000, v116
    v_mul_f32 v132, v129, v132
    v_mul_f32 v133, v128, v133
    v_fma_f32 v135, v128, v130, -v132
    v_fma_f32 v137, v129, v131, v133
    v_cvt_pk_bf16_f32 v160, v134, v135
    v_cvt_pk_bf16_f32 v164, v136, v137
    v_lshlrev_b32 v128, 16, v17
    v_lshlrev_b32 v129, 16, v21
    v_lshlrev_b32 v130, 16, v49
    v_lshlrev_b32 v131, 16, v53
    v_lshlrev_b32 v132, 16, v113
    v_lshlrev_b32 v133, 16, v117
    v_mul_f32 v132, v129, v132
    v_mul_f32 v133, v128, v133
    v_fma_f32 v134, v128, v130, -v132
    v_fma_f32 v136, v129, v131, v133
    v_and_b32 v128, 0xffff0000, v17
    v_and_b32 v129, 0xffff0000, v21
    v_and_b32 v130, 0xffff0000, v49
    v_and_b32 v131, 0xffff0000, v53
    v_and_b32 v132, 0xffff0000, v113
    v_and_b32 v133, 0xffff0000, v117
    v_mul_f32 v132, v129, v132
    v_mul_f32 v133, v128, v133
    v_fma_f32 v135, v128, v130, -v132
    v_fma_f32 v137, v129, v131, v133
    v_cvt_pk_bf16_f32 v161, v134, v135
    v_cvt_pk_bf16_f32 v165, v136, v137
    v_lshlrev_b32 v128, 16, v18
    v_lshlrev_b32 v129, 16, v22
    v_lshlrev_b32 v130, 16, v50
    v_lshlrev_b32 v131, 16, v54
    v_lshlrev_b32 v132, 16, v114
    v_lshlrev_b32 v133, 16, v118
    v_mul_f32 v132, v129, v132
    v_mul_f32 v133, v128, v133
    v_fma_f32 v134, v128, v130, -v132
    v_fma_f32 v136, v129, v131, v133
    v_and_b32 v128, 0xffff0000, v18
    v_and_b32 v129, 0xffff0000, v22
    v_and_b32 v130, 0xffff0000, v50
    v_and_b32 v131, 0xffff0000, v54
    v_and_b32 v132, 0xffff0000, v114
    v_and_b32 v133, 0xffff0000, v118
    v_mul_f32 v132, v129, v132
    v_mul_f32 v133, v128, v133
    v_fma_f32 v135, v128, v130, -v132
    v_fma_f32 v137, v129, v131, v133
    v_cvt_pk_bf16_f32 v162, v134, v135
    v_cvt_pk_bf16_f32 v166, v136, v137
    v_lshlrev_b32 v128, 16, v19
    v_lshlrev_b32 v129, 16, v23
    v_lshlrev_b32 v130, 16, v51
    v_lshlrev_b32 v131, 16, v55
    v_lshlrev_b32 v132, 16, v115
    v_lshlrev_b32 v133, 16, v119
    v_mul_f32 v132, v129, v132
    v_mul_f32 v133, v128, v133
    v_fma_f32 v134, v128, v130, -v132
    v_fma_f32 v136, v129, v131, v133
    v_and_b32 v128, 0xffff0000, v19
    v_and_b32 v129, 0xffff0000, v23
    v_and_b32 v130, 0xffff0000, v51
    v_and_b32 v131, 0xffff0000, v55
    v_and_b32 v132, 0xffff0000, v115
    v_and_b32 v133, 0xffff0000, v119
    v_mul_f32 v132, v129, v132
    v_mul_f32 v133, v128, v133
    v_fma_f32 v135, v128, v130, -v132
    v_fma_f32 v137, v129, v131, v133
    v_cvt_pk_bf16_f32 v163, v134, v135
    v_cvt_pk_bf16_f32 v167, v136, v137
    ds_write_b128 v176, v[160:163] offset:4096
    ds_write_b128 v177, v[164:167] offset:4096
    s_waitcnt vmcnt(0)
    v_lshlrev_b32 v128, 16, v24
    v_lshlrev_b32 v129, 16, v28
    v_lshlrev_b32 v130, 16, v56
    v_lshlrev_b32 v131, 16, v60
    v_lshlrev_b32 v132, 16, v120
    v_lshlrev_b32 v133, 16, v124
    v_mul_f32 v132, v129, v132
    v_mul_f32 v133, v128, v133
    v_fma_f32 v134, v128, v130, -v132
    v_fma_f32 v136, v129, v131, v133
    v_and_b32 v128, 0xffff0000, v24
    v_and_b32 v129, 0xffff0000, v28
    v_and_b32 v130, 0xffff0000, v56
    v_and_b32 v131, 0xffff0000, v60
    v_and_b32 v132, 0xffff0000, v120
    v_and_b32 v133, 0xffff0000, v124
    v_mul_f32 v132, v129, v132
    v_mul_f32 v133, v128, v133
    v_fma_f32 v135, v128, v130, -v132
    v_fma_f32 v137, v129, v131, v133
    v_cvt_pk_bf16_f32 v168, v134, v135
    v_cvt_pk_bf16_f32 v172, v136, v137
    v_lshlrev_b32 v128, 16, v25
    v_lshlrev_b32 v129, 16, v29
    v_lshlrev_b32 v130, 16, v57
    v_lshlrev_b32 v131, 16, v61
    v_lshlrev_b32 v132, 16, v121
    v_lshlrev_b32 v133, 16, v125
    v_mul_f32 v132, v129, v132
    v_mul_f32 v133, v128, v133
    v_fma_f32 v134, v128, v130, -v132
    v_fma_f32 v136, v129, v131, v133
    v_and_b32 v128, 0xffff0000, v25
    v_and_b32 v129, 0xffff0000, v29
    v_and_b32 v130, 0xffff0000, v57
    v_and_b32 v131, 0xffff0000, v61
    v_and_b32 v132, 0xffff0000, v121
    v_and_b32 v133, 0xffff0000, v125
    v_mul_f32 v132, v129, v132
    v_mul_f32 v133, v128, v133
    v_fma_f32 v135, v128, v130, -v132
    v_fma_f32 v137, v129, v131, v133
    v_cvt_pk_bf16_f32 v169, v134, v135
    v_cvt_pk_bf16_f32 v173, v136, v137
    v_lshlrev_b32 v128, 16, v26
    v_lshlrev_b32 v129, 16, v30
    v_lshlrev_b32 v130, 16, v58
    v_lshlrev_b32 v131, 16, v62
    v_lshlrev_b32 v132, 16, v122
    v_lshlrev_b32 v133, 16, v126
    v_mul_f32 v132, v129, v132
    v_mul_f32 v133, v128, v133
    v_fma_f32 v134, v128, v130, -v132
    v_fma_f32 v136, v129, v131, v133
    v_and_b32 v128, 0xffff0000, v26
    v_and_b32 v129, 0xffff0000, v30
    v_and_b32 v130, 0xffff0000, v58
    v_and_b32 v131, 0xffff0000, v62
    v_and_b32 v132, 0xffff0000, v122
    v_and_b32 v133, 0xffff0000, v126
    v_mul_f32 v132, v129, v132
    v_mul_f32 v133, v128, v133
    v_fma_f32 v135, v128, v130, -v132
    v_fma_f32 v137, v129, v131, v133
    v_cvt_pk_bf16_f32 v170, v134, v135
    v_cvt_pk_bf16_f32 v174, v136, v137
    v_lshlrev_b32 v128, 16, v27
    v_lshlrev_b32 v129, 16, v31
    v_lshlrev_b32 v130, 16, v59
    v_lshlrev_b32 v131, 16, v63
    v_lshlrev_b32 v132, 16, v123
    v_lshlrev_b32 v133, 16, v127
    v_mul_f32 v132, v129, v132
    v_mul_f32 v133, v128, v133
    v_fma_f32 v134, v128, v130, -v132
    v_fma_f32 v136, v129, v131, v133
    v_and_b32 v128, 0xffff0000, v27
    v_and_b32 v129, 0xffff0000, v31
    v_and_b32 v130, 0xffff0000, v59
    v_and_b32 v131, 0xffff0000, v63
    v_and_b32 v132, 0xffff0000, v123
    v_and_b32 v133, 0xffff0000, v127
    v_mul_f32 v132, v129, v132
    v_mul_f32 v133, v128, v133
    v_fma_f32 v135, v128, v130, -v132
    v_fma_f32 v137, v129, v131, v133
    v_cvt_pk_bf16_f32 v171, v134, v135
    v_cvt_pk_bf16_f32 v175, v136, v137
    ds_write_b128 v177, v[168:171] offset:6144
    ds_write_b128 v176, v[172:175] offset:6144
    s_waitcnt lgkmcnt(0)
    ds_read_b64 v[64:65], v178 offset:0
    ds_read_b64 v[66:67], v180 offset:0
    ds_read_b64 v[68:69], v178 offset:8
    ds_read_b64 v[70:71], v180 offset:8
    ds_read_b64 v[72:73], v179 offset:0
    ds_read_b64 v[74:75], v181 offset:0
    ds_read_b64 v[76:77], v179 offset:8
    ds_read_b64 v[78:79], v181 offset:8
    ds_read_b64 v[80:81], v178 offset:4096
    ds_read_b64 v[82:83], v180 offset:4096
    ds_read_b64 v[84:85], v178 offset:4104
    ds_read_b64 v[86:87], v180 offset:4104
    ds_read_b64 v[88:89], v179 offset:4096
    ds_read_b64 v[90:91], v181 offset:4096
    ds_read_b64 v[92:93], v179 offset:4104
    ds_read_b64 v[94:95], v181 offset:4104
    s_waitcnt lgkmcnt(0)
    v_mov_b32 v176, 0
    v_mov_b32 v177, 0
    v_mov_b32 v178, 0
    v_mov_b32 v179, 0
    v_mov_b32 v180, 0
    v_mov_b32 v181, 0
    v_mov_b32 v182, 0
    v_mov_b32 v183, 0
standalone__kv_cache_quant_pre_rope_vs_post_rope__prompt_kernel_main:
    v_mov_b32 v0, 0
    v_mov_b32 v1, 0
    v_mov_b32 v2, 0
    v_mov_b32 v3, 0
    v_mov_b32 v4, 0
    v_mov_b32 v5, 0
    v_mov_b32 v6, 0
    v_mov_b32 v7, 0
    v_mov_b32 v8, 0
    v_mov_b32 v9, 0
    v_mov_b32 v10, 0
    v_mov_b32 v11, 0
    v_mov_b32 v12, 0
    v_mov_b32 v13, 0
    v_mov_b32 v14, 0
    v_mov_b32 v15, 0
    v_mov_b32 v16, 0
    v_mov_b32 v17, 0
    v_mov_b32 v18, 0
    v_mov_b32 v19, 0
    v_mov_b32 v20, 0
    v_mov_b32 v21, 0
    v_mov_b32 v22, 0
    v_mov_b32 v23, 0
    v_mov_b32 v24, 0
    v_mov_b32 v25, 0
    v_mov_b32 v26, 0
    v_mov_b32 v27, 0
    v_mov_b32 v28, 0
    v_mov_b32 v29, 0
    v_mov_b32 v30, 0
    v_mov_b32 v31, 0
    v_mov_b32 v32, 0
    v_mov_b32 v33, 0
    v_mov_b32 v34, 0
    v_mov_b32 v35, 0
    v_mov_b32 v36, 0
    v_mov_b32 v37, 0
    v_mov_b32 v38, 0
    v_mov_b32 v39, 0
    v_mov_b32 v40, 0
    v_mov_b32 v41, 0
    v_mov_b32 v42, 0
    v_mov_b32 v43, 0
    v_mov_b32 v44, 0
    v_mov_b32 v45, 0
    v_mov_b32 v46, 0
    v_mov_b32 v47, 0
    v_mov_b32 v48, 0
    v_mov_b32 v49, 0
    v_mov_b32 v50, 0
    v_mov_b32 v51, 0
    v_mov_b32 v52, 0
    v_mov_b32 v53, 0
    v_mov_b32 v54, 0
    v_mov_b32 v55, 0
    v_mov_b32 v56, 0
    v_mov_b32 v57, 0
    v_mov_b32 v58, 0
    v_mov_b32 v59, 0
    v_mov_b32 v60, 0
    v_mov_b32 v61, 0
    v_mov_b32 v62, 0
    v_mov_b32 v63, 0
    v_mov_b32 v184, 0
    v_mov_b32 v185, 0
    v_mov_b32 v186, 0
    v_mov_b32 v187, 0
    v_mov_b32 v188, 0
    v_mov_b32 v189, 0
    v_mov_b32 v190, 0
    v_mov_b32 v191, 0
    v_mov_b32 v196, v199
    v_add_u32 v197, 0x8000, v199
    s_waitcnt lgkmcnt(0)
    s_barrier
    ds_read_b128 v[144:147], v196 offset:16384
    ds_read_b128 v[148:151], v196 offset:17408
    ds_read_b128 v[152:155], v196 offset:18432
    ds_read_b128 v[156:159], v196 offset:19456
    ds_read_b128 v[160:163], v196 offset:20480
    ds_read_b128 v[164:167], v196 offset:21504
    s_waitcnt lgkmcnt(4)
    v_mfma_f32_16x16x32_bf16 v[96:99], v[144:147], v[64:67], v[176:179]
    v_mfma_f32_16x16x32_bf16 v[100:103], v[144:147], v[80:83], v[180:183]
    ds_read_b128 v[168:171], v196 offset:22528
    v_mfma_f32_16x16x32_bf16 v[96:99], v[148:151], v[68:71], v[96:99]
    v_mfma_f32_16x16x32_bf16 v[100:103], v[148:151], v[84:87], v[100:103]
    ds_read_b128 v[172:175], v196 offset:23552
    s_waitcnt lgkmcnt(4)
    v_mfma_f32_16x16x32_bf16 v[96:99], v[152:155], v[72:75], v[96:99]
    v_mfma_f32_16x16x32_bf16 v[100:103], v[152:155], v[88:91], v[100:103]
    ds_read_b128 v[144:147], v196 offset:24576
    v_mfma_f32_16x16x32_bf16 v[96:99], v[156:159], v[76:79], v[96:99]
    v_mfma_f32_16x16x32_bf16 v[100:103], v[156:159], v[92:95], v[100:103]
    ds_read_b128 v[148:151], v196 offset:25600
    s_waitcnt lgkmcnt(4)
    v_mfma_f32_16x16x32_bf16 v[104:107], v[160:163], v[64:67], v[176:179]
    v_mfma_f32_16x16x32_bf16 v[108:111], v[160:163], v[80:83], v[180:183]
    ds_read_b128 v[152:155], v196 offset:26624
    v_mfma_f32_16x16x32_bf16 v[104:107], v[164:167], v[68:71], v[104:107]
    v_mfma_f32_16x16x32_bf16 v[108:111], v[164:167], v[84:87], v[108:111]
    ds_read_b128 v[156:159], v196 offset:27648
    s_waitcnt lgkmcnt(4)
    v_mfma_f32_16x16x32_bf16 v[104:107], v[168:171], v[72:75], v[104:107]
    v_mfma_f32_16x16x32_bf16 v[108:111], v[168:171], v[88:91], v[108:111]
    ds_read_b128 v[160:163], v196 offset:28672
    v_mfma_f32_16x16x32_bf16 v[104:107], v[172:175], v[76:79], v[104:107]
    v_mfma_f32_16x16x32_bf16 v[108:111], v[172:175], v[92:95], v[108:111]
    ds_read_b128 v[164:167], v196 offset:29696
    s_waitcnt lgkmcnt(4)
    s_nop 15
    ds_read_b128 v[168:171], v196 offset:30720
    ds_read_b128 v[172:175], v196 offset:31744
    s_waitcnt lgkmcnt(4)
    s_barrier
    ds_read_b128 v[144:147], v197 offset:0
    ds_read_b128 v[148:151], v197 offset:1024
    s_waitcnt lgkmcnt(4)
    v_xor_b32 v196, 0x10000, v196
    v_exp_f32 v96, v96
    ds_read_b128 v[152:155], v197 offset:2048
    v_exp_f32 v97, v97
    ds_read_b128 v[156:159], v197 offset:3072
    s_waitcnt lgkmcnt(4)
    v_exp_f32 v98, v98
    ds_read_b128 v[160:163], v197 offset:4096
    v_exp_f32 v99, v99
    ds_read_b128 v[164:167], v197 offset:5120
    v_cvt_pk_bf16_f32 v128, v96, v97
    s_waitcnt lgkmcnt(4)
    v_mfma_f32_16x16x32_bf16 v[112:115], v[144:147], v[64:67], v[176:179]
    v_exp_f32 v100, v100
    v_mfma_f32_16x16x32_bf16 v[116:119], v[144:147], v[80:83], v[180:183]
    ds_read_b128 v[168:171], v197 offset:6144
    v_cvt_pk_bf16_f32 v129, v98, v99
    v_mfma_f32_16x16x32_bf16 v[112:115], v[148:151], v[68:71], v[112:115]
    v_exp_f32 v101, v101
    v_mfma_f32_16x16x32_bf16 v[116:119], v[148:151], v[84:87], v[116:119]
    ds_read_b128 v[172:175], v197 offset:7168
    s_waitcnt lgkmcnt(4)
    v_mfma_f32_16x16x32_bf16 v[112:115], v[152:155], v[72:75], v[112:115]
    v_exp_f32 v102, v102
    v_mfma_f32_16x16x32_bf16 v[116:119], v[152:155], v[88:91], v[116:119]
    ds_read_b128 v[144:147], v197 offset:8192
    v_cvt_pk_bf16_f32 v132, v100, v101
    v_mfma_f32_16x16x32_bf16 v[112:115], v[156:159], v[76:79], v[112:115]
    v_exp_f32 v103, v103
    v_mfma_f32_16x16x32_bf16 v[116:119], v[156:159], v[92:95], v[116:119]
    ds_read_b128 v[148:151], v197 offset:9216
    s_waitcnt lgkmcnt(4)
    v_mfma_f32_16x16x32_bf16 v[120:123], v[160:163], v[64:67], v[176:179]
    v_exp_f32 v104, v104
    v_mfma_f32_16x16x32_bf16 v[124:127], v[160:163], v[80:83], v[180:183]
    ds_read_b128 v[152:155], v197 offset:10240
    v_cvt_pk_bf16_f32 v133, v102, v103
    v_mfma_f32_16x16x32_bf16 v[120:123], v[164:167], v[68:71], v[120:123]
    v_exp_f32 v105, v105
    v_mfma_f32_16x16x32_bf16 v[124:127], v[164:167], v[84:87], v[124:127]
    ds_read_b128 v[156:159], v197 offset:11264
    s_waitcnt lgkmcnt(4)
    v_mfma_f32_16x16x32_bf16 v[120:123], v[168:171], v[72:75], v[120:123]
    v_exp_f32 v106, v106
    v_mfma_f32_16x16x32_bf16 v[124:127], v[168:171], v[88:91], v[124:127]
    ds_read_b128 v[160:163], v197 offset:12288
    v_cvt_pk_bf16_f32 v130, v104, v105
    v_mfma_f32_16x16x32_bf16 v[120:123], v[172:175], v[76:79], v[120:123]
    v_exp_f32 v107, v107
    v_mfma_f32_16x16x32_bf16 v[124:127], v[172:175], v[92:95], v[124:127]
    ds_read_b128 v[164:167], v197 offset:13312
    s_waitcnt lgkmcnt(4)
    s_nop 15
    v_exp_f32 v108, v108
    ds_read_b128 v[168:171], v197 offset:14336
    v_cvt_pk_bf16_f32 v131, v106, v107
    v_exp_f32 v109, v109
    ds_read_b128 v[172:175], v197 offset:15360
    s_waitcnt lgkmcnt(4)
    v_exp_f32 v110, v110
    ds_read_b128 v[144:147], v197 offset:16384
    v_cvt_pk_bf16_f32 v134, v108, v109
    v_exp_f32 v111, v111
    ds_read_b128 v[148:151], v197 offset:17408
    s_waitcnt lgkmcnt(4)
    v_exp_f32 v112, v112
    ds_read_b128 v[152:155], v197 offset:18432
    v_cvt_pk_bf16_f32 v135, v110, v111
    v_exp_f32 v113, v113
    ds_read_b128 v[156:159], v197 offset:19456
    s_waitcnt lgkmcnt(4)
    v_exp_f32 v114, v114
    ds_read_b128 v[160:163], v197 offset:20480
    v_exp_f32 v115, v115
    ds_read_b128 v[164:167], v197 offset:21504
    v_cvt_pk_bf16_f32 v136, v112, v113
    s_waitcnt lgkmcnt(4)
    v_mfma_f32_16x16x32_bf16 v[96:99], v[144:147], v[64:67], v[176:179]
    v_exp_f32 v116, v116
    v_mfma_f32_16x16x32_bf16 v[100:103], v[144:147], v[80:83], v[180:183]
    ds_read_b128 v[168:171], v197 offset:22528
    v_cvt_pk_bf16_f32 v137, v114, v115
    v_mfma_f32_16x16x32_bf16 v[96:99], v[148:151], v[68:71], v[96:99]
    v_exp_f32 v117, v117
    v_mfma_f32_16x16x32_bf16 v[100:103], v[148:151], v[84:87], v[100:103]
    ds_read_b128 v[172:175], v197 offset:23552
    s_waitcnt lgkmcnt(4)
    v_mfma_f32_16x16x32_bf16 v[96:99], v[152:155], v[72:75], v[96:99]
    v_exp_f32 v118, v118
    v_mfma_f32_16x16x32_bf16 v[100:103], v[152:155], v[88:91], v[100:103]
    ds_read_b128 v[144:147], v197 offset:24576
    v_cvt_pk_bf16_f32 v140, v116, v117
    v_mfma_f32_16x16x32_bf16 v[96:99], v[156:159], v[76:79], v[96:99]
    v_exp_f32 v119, v119
    v_mfma_f32_16x16x32_bf16 v[100:103], v[156:159], v[92:95], v[100:103]
    ds_read_b128 v[148:151], v197 offset:25600
    s_waitcnt lgkmcnt(4)
    v_mfma_f32_16x16x32_bf16 v[104:107], v[160:163], v[64:67], v[176:179]
    v_exp_f32 v120, v120
    v_mfma_f32_16x16x32_bf16 v[108:111], v[160:163], v[80:83], v[180:183]
    ds_read_b128 v[152:155], v197 offset:26624
    v_cvt_pk_bf16_f32 v141, v118, v119
    v_mfma_f32_16x16x32_bf16 v[104:107], v[164:167], v[68:71], v[104:107]
    v_exp_f32 v121, v121
    v_mfma_f32_16x16x32_bf16 v[108:111], v[164:167], v[84:87], v[108:111]
    ds_read_b128 v[156:159], v197 offset:27648
    s_waitcnt lgkmcnt(4)
    v_mfma_f32_16x16x32_bf16 v[104:107], v[168:171], v[72:75], v[104:107]
    v_exp_f32 v122, v122
    v_mfma_f32_16x16x32_bf16 v[108:111], v[168:171], v[88:91], v[108:111]
    ds_read_b128 v[160:163], v197 offset:28672
    v_cvt_pk_bf16_f32 v138, v120, v121
    v_mfma_f32_16x16x32_bf16 v[104:107], v[172:175], v[76:79], v[104:107]
    v_exp_f32 v123, v123
    v_mfma_f32_16x16x32_bf16 v[108:111], v[172:175], v[92:95], v[108:111]
    ds_read_b128 v[164:167], v197 offset:29696
    s_waitcnt lgkmcnt(4)
    v_mfma_f32_16x16x32_bf16 v[0:3], v[144:147], v[128:131], v[0:3]
    v_exp_f32 v124, v124
    v_mfma_f32_16x16x32_bf16 v[4:7], v[144:147], v[132:135], v[4:7]
    ds_read_b128 v[168:171], v197 offset:30720
    v_cvt_pk_bf16_f32 v139, v122, v123
    v_mfma_f32_16x16x32_bf16 v[8:11], v[148:151], v[128:131], v[8:11]
    v_exp_f32 v125, v125
    v_mfma_f32_16x16x32_bf16 v[12:15], v[148:151], v[132:135], v[12:15]
    ds_read_b128 v[172:175], v197 offset:31744
    s_waitcnt lgkmcnt(4)
    v_mfma_f32_16x16x32_bf16 v[184:187], v[192:195], v[128:131], v[184:187]
    v_mfma_f32_16x16x32_bf16 v[16:19], v[152:155], v[128:131], v[16:19]
    v_exp_f32 v126, v126
    v_mfma_f32_16x16x32_bf16 v[20:23], v[152:155], v[132:135], v[20:23]
    s_barrier
    ds_read_b128 v[144:147], v196 offset:0
    v_cvt_pk_bf16_f32 v142, v124, v125
    v_mfma_f32_16x16x32_bf16 v[24:27], v[156:159], v[128:131], v[24:27]
    v_exp_f32 v127, v127
    v_mfma_f32_16x16x32_bf16 v[28:31], v[156:159], v[132:135], v[28:31]
    ds_read_b128 v[148:151], v196 offset:1024
    s_waitcnt lgkmcnt(4)
    v_xor_b32 v197, 0x10000, v197
    v_mfma_f32_16x16x32_bf16 v[32:35], v[160:163], v[128:131], v[32:35]
    v_exp_f32 v96, v96
    v_mfma_f32_16x16x32_bf16 v[36:39], v[160:163], v[132:135], v[36:39]
    ds_read_b128 v[152:155], v196 offset:2048
    v_cvt_pk_bf16_f32 v143, v126, v127
    v_mfma_f32_16x16x32_bf16 v[40:43], v[164:167], v[128:131], v[40:43]
    v_exp_f32 v97, v97
    v_mfma_f32_16x16x32_bf16 v[44:47], v[164:167], v[132:135], v[44:47]
    ds_read_b128 v[156:159], v196 offset:3072
    s_waitcnt lgkmcnt(4)
    v_mfma_f32_16x16x32_bf16 v[188:191], v[192:195], v[132:135], v[188:191]
    v_mfma_f32_16x16x32_bf16 v[48:51], v[168:171], v[128:131], v[48:51]
    v_exp_f32 v98, v98
    v_mfma_f32_16x16x32_bf16 v[52:55], v[168:171], v[132:135], v[52:55]
    ds_read_b128 v[160:163], v196 offset:4096
    v_mfma_f32_16x16x32_bf16 v[56:59], v[172:175], v[128:131], v[56:59]
    v_exp_f32 v99, v99
    v_mfma_f32_16x16x32_bf16 v[60:63], v[172:175], v[132:135], v[60:63]
    ds_read_b128 v[164:167], v196 offset:5120
    v_cvt_pk_bf16_f32 v128, v96, v97
    s_waitcnt lgkmcnt(4)
    s_mov_b32 s18, 0
standalone__kv_cache_quant_pre_rope_vs_post_rope__prompt_kernel_loop:
    v_mfma_f32_16x16x32_bf16 v[112:115], v[144:147], v[64:67], v[176:179]
    v_exp_f32 v100, v100
    v_mfma_f32_16x16x32_bf16 v[116:119], v[144:147], v[80:83], v[180:183]
    ds_read_b128 v[168:171], v196 offset:6144
    v_cvt_pk_bf16_f32 v129, v98, v99
    v_mfma_f32_16x16x32_bf16 v[112:115], v[148:151], v[68:71], v[112:115]
    v_exp_f32 v101, v101
    v_mfma_f32_16x16x32_bf16 v[116:119], v[148:151], v[84:87], v[116:119]
    ds_read_b128 v[172:175], v196 offset:7168
    s_waitcnt lgkmcnt(4)
    v_mfma_f32_16x16x32_bf16 v[112:115], v[152:155], v[72:75], v[112:115]
    v_exp_f32 v102, v102
    v_mfma_f32_16x16x32_bf16 v[116:119], v[152:155], v[88:91], v[116:119]
    ds_read_b128 v[144:147], v196 offset:8192
    v_cvt_pk_bf16_f32 v132, v100, v101
    v_mfma_f32_16x16x32_bf16 v[112:115], v[156:159], v[76:79], v[112:115]
    v_exp_f32 v103, v103
    v_mfma_f32_16x16x32_bf16 v[116:119], v[156:159], v[92:95], v[116:119]
    ds_read_b128 v[148:151], v196 offset:9216
    s_waitcnt lgkmcnt(4)
    v_mfma_f32_16x16x32_bf16 v[120:123], v[160:163], v[64:67], v[176:179]
    v_exp_f32 v104, v104
    v_mfma_f32_16x16x32_bf16 v[124:127], v[160:163], v[80:83], v[180:183]
    ds_read_b128 v[152:155], v196 offset:10240
    v_cvt_pk_bf16_f32 v133, v102, v103
    v_mfma_f32_16x16x32_bf16 v[120:123], v[164:167], v[68:71], v[120:123]
    v_exp_f32 v105, v105
    v_mfma_f32_16x16x32_bf16 v[124:127], v[164:167], v[84:87], v[124:127]
    ds_read_b128 v[156:159], v196 offset:11264
    s_waitcnt lgkmcnt(4)
    v_mfma_f32_16x16x32_bf16 v[120:123], v[168:171], v[72:75], v[120:123]
    v_exp_f32 v106, v106
    v_mfma_f32_16x16x32_bf16 v[124:127], v[168:171], v[88:91], v[124:127]
    ds_read_b128 v[160:163], v196 offset:12288
    v_cvt_pk_bf16_f32 v130, v104, v105
    v_mfma_f32_16x16x32_bf16 v[120:123], v[172:175], v[76:79], v[120:123]
    v_exp_f32 v107, v107
    v_mfma_f32_16x16x32_bf16 v[124:127], v[172:175], v[92:95], v[124:127]
    ds_read_b128 v[164:167], v196 offset:13312
    s_waitcnt lgkmcnt(4)
    v_mfma_f32_16x16x32_bf16 v[0:3], v[144:147], v[136:139], v[0:3]
    v_exp_f32 v108, v108
    v_mfma_f32_16x16x32_bf16 v[4:7], v[144:147], v[140:143], v[4:7]
    ds_read_b128 v[168:171], v196 offset:14336
    v_cvt_pk_bf16_f32 v131, v106, v107
    v_mfma_f32_16x16x32_bf16 v[8:11], v[148:151], v[136:139], v[8:11]
    v_exp_f32 v109, v109
    v_mfma_f32_16x16x32_bf16 v[12:15], v[148:151], v[140:143], v[12:15]
    ds_read_b128 v[172:175], v196 offset:15360
    s_waitcnt lgkmcnt(4)
    v_mfma_f32_16x16x32_bf16 v[184:187], v[192:195], v[136:139], v[184:187]
    v_mfma_f32_16x16x32_bf16 v[16:19], v[152:155], v[136:139], v[16:19]
    v_exp_f32 v110, v110
    v_mfma_f32_16x16x32_bf16 v[20:23], v[152:155], v[140:143], v[20:23]
    ds_read_b128 v[144:147], v196 offset:16384
    v_cvt_pk_bf16_f32 v134, v108, v109
    v_mfma_f32_16x16x32_bf16 v[24:27], v[156:159], v[136:139], v[24:27]
    v_exp_f32 v111, v111
    v_mfma_f32_16x16x32_bf16 v[28:31], v[156:159], v[140:143], v[28:31]
    ds_read_b128 v[148:151], v196 offset:17408
    s_waitcnt lgkmcnt(4)
    v_mfma_f32_16x16x32_bf16 v[32:35], v[160:163], v[136:139], v[32:35]
    v_exp_f32 v112, v112
    v_mfma_f32_16x16x32_bf16 v[36:39], v[160:163], v[140:143], v[36:39]
    ds_read_b128 v[152:155], v196 offset:18432
    v_cvt_pk_bf16_f32 v135, v110, v111
    v_mfma_f32_16x16x32_bf16 v[40:43], v[164:167], v[136:139], v[40:43]
    v_exp_f32 v113, v113
    v_mfma_f32_16x16x32_bf16 v[44:47], v[164:167], v[140:143], v[44:47]
    ds_read_b128 v[156:159], v196 offset:19456
    s_waitcnt lgkmcnt(4)
    v_mfma_f32_16x16x32_bf16 v[188:191], v[192:195], v[140:143], v[188:191]
    v_mfma_f32_16x16x32_bf16 v[48:51], v[168:171], v[136:139], v[48:51]
    v_exp_f32 v114, v114
    v_mfma_f32_16x16x32_bf16 v[52:55], v[168:171], v[140:143], v[52:55]
    ds_read_b128 v[160:163], v196 offset:20480
    v_mfma_f32_16x16x32_bf16 v[56:59], v[172:175], v[136:139], v[56:59]
    v_exp_f32 v115, v115
    v_mfma_f32_16x16x32_bf16 v[60:63], v[172:175], v[140:143], v[60:63]
    ds_read_b128 v[164:167], v196 offset:21504
    v_cvt_pk_bf16_f32 v136, v112, v113
    s_waitcnt lgkmcnt(4)
    v_mfma_f32_16x16x32_bf16 v[96:99], v[144:147], v[64:67], v[176:179]
    v_exp_f32 v116, v116
    v_mfma_f32_16x16x32_bf16 v[100:103], v[144:147], v[80:83], v[180:183]
    ds_read_b128 v[168:171], v196 offset:22528
    v_cvt_pk_bf16_f32 v137, v114, v115
    v_mfma_f32_16x16x32_bf16 v[96:99], v[148:151], v[68:71], v[96:99]
    v_exp_f32 v117, v117
    v_mfma_f32_16x16x32_bf16 v[100:103], v[148:151], v[84:87], v[100:103]
    ds_read_b128 v[172:175], v196 offset:23552
    s_waitcnt lgkmcnt(4)
    v_mfma_f32_16x16x32_bf16 v[96:99], v[152:155], v[72:75], v[96:99]
    v_exp_f32 v118, v118
    v_mfma_f32_16x16x32_bf16 v[100:103], v[152:155], v[88:91], v[100:103]
    ds_read_b128 v[144:147], v196 offset:24576
    v_cvt_pk_bf16_f32 v140, v116, v117
    v_mfma_f32_16x16x32_bf16 v[96:99], v[156:159], v[76:79], v[96:99]
    v_exp_f32 v119, v119
    v_mfma_f32_16x16x32_bf16 v[100:103], v[156:159], v[92:95], v[100:103]
    ds_read_b128 v[148:151], v196 offset:25600
    s_waitcnt lgkmcnt(4)
    v_mfma_f32_16x16x32_bf16 v[104:107], v[160:163], v[64:67], v[176:179]
    v_exp_f32 v120, v120
    v_mfma_f32_16x16x32_bf16 v[108:111], v[160:163], v[80:83], v[180:183]
    ds_read_b128 v[152:155], v196 offset:26624
    v_cvt_pk_bf16_f32 v141, v118, v119
    v_mfma_f32_16x16x32_bf16 v[104:107], v[164:167], v[68:71], v[104:107]
    v_exp_f32 v121, v121
    v_mfma_f32_16x16x32_bf16 v[108:111], v[164:167], v[84:87], v[108:111]
    ds_read_b128 v[156:159], v196 offset:27648
    s_waitcnt lgkmcnt(4)
    v_mfma_f32_16x16x32_bf16 v[104:107], v[168:171], v[72:75], v[104:107]
    v_exp_f32 v122, v122
    v_mfma_f32_16x16x32_bf16 v[108:111], v[168:171], v[88:91], v[108:111]
    ds_read_b128 v[160:163], v196 offset:28672
    v_cvt_pk_bf16_f32 v138, v120, v121
    v_mfma_f32_16x16x32_bf16 v[104:107], v[172:175], v[76:79], v[104:107]
    v_exp_f32 v123, v123
    v_mfma_f32_16x16x32_bf16 v[108:111], v[172:175], v[92:95], v[108:111]
    ds_read_b128 v[164:167], v196 offset:29696
    s_waitcnt lgkmcnt(4)
    v_mfma_f32_16x16x32_bf16 v[0:3], v[144:147], v[128:131], v[0:3]
    v_exp_f32 v124, v124
    v_mfma_f32_16x16x32_bf16 v[4:7], v[144:147], v[132:135], v[4:7]
    ds_read_b128 v[168:171], v196 offset:30720
    v_cvt_pk_bf16_f32 v139, v122, v123
    v_mfma_f32_16x16x32_bf16 v[8:11], v[148:151], v[128:131], v[8:11]
    v_exp_f32 v125, v125
    v_mfma_f32_16x16x32_bf16 v[12:15], v[148:151], v[132:135], v[12:15]
    ds_read_b128 v[172:175], v196 offset:31744
    s_waitcnt lgkmcnt(4)
    v_mfma_f32_16x16x32_bf16 v[184:187], v[192:195], v[128:131], v[184:187]
    v_mfma_f32_16x16x32_bf16 v[16:19], v[152:155], v[128:131], v[16:19]
    v_exp_f32 v126, v126
    v_mfma_f32_16x16x32_bf16 v[20:23], v[152:155], v[132:135], v[20:23]
    s_barrier
    ds_read_b128 v[144:147], v197 offset:0
    v_cvt_pk_bf16_f32 v142, v124, v125
    v_mfma_f32_16x16x32_bf16 v[24:27], v[156:159], v[128:131], v[24:27]
    v_exp_f32 v127, v127
    v_mfma_f32_16x16x32_bf16 v[28:31], v[156:159], v[132:135], v[28:31]
    ds_read_b128 v[148:151], v197 offset:1024
    s_waitcnt lgkmcnt(4)
    v_xor_b32 v196, 0x10000, v196
    v_mfma_f32_16x16x32_bf16 v[32:35], v[160:163], v[128:131], v[32:35]
    v_exp_f32 v96, v96
    v_mfma_f32_16x16x32_bf16 v[36:39], v[160:163], v[132:135], v[36:39]
    ds_read_b128 v[152:155], v197 offset:2048
    v_cvt_pk_bf16_f32 v143, v126, v127
    v_mfma_f32_16x16x32_bf16 v[40:43], v[164:167], v[128:131], v[40:43]
    v_exp_f32 v97, v97
    v_mfma_f32_16x16x32_bf16 v[44:47], v[164:167], v[132:135], v[44:47]
    ds_read_b128 v[156:159], v197 offset:3072
    s_waitcnt lgkmcnt(4)
    v_mfma_f32_16x16x32_bf16 v[188:191], v[192:195], v[132:135], v[188:191]
    v_mfma_f32_16x16x32_bf16 v[48:51], v[168:171], v[128:131], v[48:51]
    v_exp_f32 v98, v98
    v_mfma_f32_16x16x32_bf16 v[52:55], v[168:171], v[132:135], v[52:55]
    ds_read_b128 v[160:163], v197 offset:4096
    v_mfma_f32_16x16x32_bf16 v[56:59], v[172:175], v[128:131], v[56:59]
    v_exp_f32 v99, v99
    v_mfma_f32_16x16x32_bf16 v[60:63], v[172:175], v[132:135], v[60:63]
    ds_read_b128 v[164:167], v197 offset:5120
    v_cvt_pk_bf16_f32 v128, v96, v97
    s_waitcnt lgkmcnt(4)
    v_mfma_f32_16x16x32_bf16 v[112:115], v[144:147], v[64:67], v[176:179]
    v_exp_f32 v100, v100
    v_mfma_f32_16x16x32_bf16 v[116:119], v[144:147], v[80:83], v[180:183]
    ds_read_b128 v[168:171], v197 offset:6144
    v_cvt_pk_bf16_f32 v129, v98, v99
    v_mfma_f32_16x16x32_bf16 v[112:115], v[148:151], v[68:71], v[112:115]
    v_exp_f32 v101, v101
    v_mfma_f32_16x16x32_bf16 v[116:119], v[148:151], v[84:87], v[116:119]
    ds_read_b128 v[172:175], v197 offset:7168
    s_waitcnt lgkmcnt(4)
    v_mfma_f32_16x16x32_bf16 v[112:115], v[152:155], v[72:75], v[112:115]
    v_exp_f32 v102, v102
    v_mfma_f32_16x16x32_bf16 v[116:119], v[152:155], v[88:91], v[116:119]
    ds_read_b128 v[144:147], v197 offset:8192
    v_cvt_pk_bf16_f32 v132, v100, v101
    v_mfma_f32_16x16x32_bf16 v[112:115], v[156:159], v[76:79], v[112:115]
    v_exp_f32 v103, v103
    v_mfma_f32_16x16x32_bf16 v[116:119], v[156:159], v[92:95], v[116:119]
    ds_read_b128 v[148:151], v197 offset:9216
    s_waitcnt lgkmcnt(4)
    v_mfma_f32_16x16x32_bf16 v[120:123], v[160:163], v[64:67], v[176:179]
    v_exp_f32 v104, v104
    v_mfma_f32_16x16x32_bf16 v[124:127], v[160:163], v[80:83], v[180:183]
    ds_read_b128 v[152:155], v197 offset:10240
    v_cvt_pk_bf16_f32 v133, v102, v103
    v_mfma_f32_16x16x32_bf16 v[120:123], v[164:167], v[68:71], v[120:123]
    v_exp_f32 v105, v105
    v_mfma_f32_16x16x32_bf16 v[124:127], v[164:167], v[84:87], v[124:127]
    ds_read_b128 v[156:159], v197 offset:11264
    s_waitcnt lgkmcnt(4)
    v_mfma_f32_16x16x32_bf16 v[120:123], v[168:171], v[72:75], v[120:123]
    v_exp_f32 v106, v106
    v_mfma_f32_16x16x32_bf16 v[124:127], v[168:171], v[88:91], v[124:127]
    ds_read_b128 v[160:163], v197 offset:12288
    v_cvt_pk_bf16_f32 v130, v104, v105
    v_mfma_f32_16x16x32_bf16 v[120:123], v[172:175], v[76:79], v[120:123]
    v_exp_f32 v107, v107
    v_mfma_f32_16x16x32_bf16 v[124:127], v[172:175], v[92:95], v[124:127]
    ds_read_b128 v[164:167], v197 offset:13312
    s_waitcnt lgkmcnt(4)
    v_mfma_f32_16x16x32_bf16 v[0:3], v[144:147], v[136:139], v[0:3]
    v_exp_f32 v108, v108
    v_mfma_f32_16x16x32_bf16 v[4:7], v[144:147], v[140:143], v[4:7]
    ds_read_b128 v[168:171], v197 offset:14336
    v_cvt_pk_bf16_f32 v131, v106, v107
    v_mfma_f32_16x16x32_bf16 v[8:11], v[148:151], v[136:139], v[8:11]
    v_exp_f32 v109, v109
    v_mfma_f32_16x16x32_bf16 v[12:15], v[148:151], v[140:143], v[12:15]
    ds_read_b128 v[172:175], v197 offset:15360
    s_waitcnt lgkmcnt(4)
    v_mfma_f32_16x16x32_bf16 v[184:187], v[192:195], v[136:139], v[184:187]
    v_mfma_f32_16x16x32_bf16 v[16:19], v[152:155], v[136:139], v[16:19]
    v_exp_f32 v110, v110
    v_mfma_f32_16x16x32_bf16 v[20:23], v[152:155], v[140:143], v[20:23]
    ds_read_b128 v[144:147], v197 offset:16384
    v_cvt_pk_bf16_f32 v134, v108, v109
    v_mfma_f32_16x16x32_bf16 v[24:27], v[156:159], v[136:139], v[24:27]
    v_exp_f32 v111, v111
    v_mfma_f32_16x16x32_bf16 v[28:31], v[156:159], v[140:143], v[28:31]
    ds_read_b128 v[148:151], v197 offset:17408
    s_waitcnt lgkmcnt(4)
    v_mfma_f32_16x16x32_bf16 v[32:35], v[160:163], v[136:139], v[32:35]
    v_exp_f32 v112, v112
    v_mfma_f32_16x16x32_bf16 v[36:39], v[160:163], v[140:143], v[36:39]
    ds_read_b128 v[152:155], v197 offset:18432
    v_cvt_pk_bf16_f32 v135, v110, v111
    v_mfma_f32_16x16x32_bf16 v[40:43], v[164:167], v[136:139], v[40:43]
    v_exp_f32 v113, v113
    v_mfma_f32_16x16x32_bf16 v[44:47], v[164:167], v[140:143], v[44:47]
    ds_read_b128 v[156:159], v197 offset:19456
    s_waitcnt lgkmcnt(4)
    v_mfma_f32_16x16x32_bf16 v[188:191], v[192:195], v[140:143], v[188:191]
    v_mfma_f32_16x16x32_bf16 v[48:51], v[168:171], v[136:139], v[48:51]
    v_exp_f32 v114, v114
    v_mfma_f32_16x16x32_bf16 v[52:55], v[168:171], v[140:143], v[52:55]
    ds_read_b128 v[160:163], v197 offset:20480
    v_mfma_f32_16x16x32_bf16 v[56:59], v[172:175], v[136:139], v[56:59]
    v_exp_f32 v115, v115
    v_mfma_f32_16x16x32_bf16 v[60:63], v[172:175], v[140:143], v[60:63]
    ds_read_b128 v[164:167], v197 offset:21504
    v_cvt_pk_bf16_f32 v136, v112, v113
    s_waitcnt lgkmcnt(4)
    v_mfma_f32_16x16x32_bf16 v[96:99], v[144:147], v[64:67], v[176:179]
    v_exp_f32 v116, v116
    v_mfma_f32_16x16x32_bf16 v[100:103], v[144:147], v[80:83], v[180:183]
    ds_read_b128 v[168:171], v197 offset:22528
    v_cvt_pk_bf16_f32 v137, v114, v115
    v_mfma_f32_16x16x32_bf16 v[96:99], v[148:151], v[68:71], v[96:99]
    v_exp_f32 v117, v117
    v_mfma_f32_16x16x32_bf16 v[100:103], v[148:151], v[84:87], v[100:103]
    ds_read_b128 v[172:175], v197 offset:23552
    s_waitcnt lgkmcnt(4)
    v_mfma_f32_16x16x32_bf16 v[96:99], v[152:155], v[72:75], v[96:99]
    v_exp_f32 v118, v118
    v_mfma_f32_16x16x32_bf16 v[100:103], v[152:155], v[88:91], v[100:103]
    ds_read_b128 v[144:147], v197 offset:24576
    v_cvt_pk_bf16_f32 v140, v116, v117
    v_mfma_f32_16x16x32_bf16 v[96:99], v[156:159], v[76:79], v[96:99]
    v_exp_f32 v119, v119
    v_mfma_f32_16x16x32_bf16 v[100:103], v[156:159], v[92:95], v[100:103]
    ds_read_b128 v[148:151], v197 offset:25600
    s_waitcnt lgkmcnt(4)
    v_mfma_f32_16x16x32_bf16 v[104:107], v[160:163], v[64:67], v[176:179]
    v_exp_f32 v120, v120
    v_mfma_f32_16x16x32_bf16 v[108:111], v[160:163], v[80:83], v[180:183]
    ds_read_b128 v[152:155], v197 offset:26624
    v_cvt_pk_bf16_f32 v141, v118, v119
    v_mfma_f32_16x16x32_bf16 v[104:107], v[164:167], v[68:71], v[104:107]
    v_exp_f32 v121, v121
    v_mfma_f32_16x16x32_bf16 v[108:111], v[164:167], v[84:87], v[108:111]
    ds_read_b128 v[156:159], v197 offset:27648
    s_waitcnt lgkmcnt(4)
    v_mfma_f32_16x16x32_bf16 v[104:107], v[168:171], v[72:75], v[104:107]
    v_exp_f32 v122, v122
    v_mfma_f32_16x16x32_bf16 v[108:111], v[168:171], v[88:91], v[108:111]
    ds_read_b128 v[160:163], v197 offset:28672
    v_cvt_pk_bf16_f32 v138, v120, v121
    v_mfma_f32_16x16x32_bf16 v[104:107], v[172:175], v[76:79], v[104:107]
    v_exp_f32 v123, v123
    v_mfma_f32_16x16x32_bf16 v[108:111], v[172:175], v[92:95], v[108:111]
    ds_read_b128 v[164:167], v197 offset:29696
    s_waitcnt lgkmcnt(4)
    v_mfma_f32_16x16x32_bf16 v[0:3], v[144:147], v[128:131], v[0:3]
    v_exp_f32 v124, v124
    v_mfma_f32_16x16x32_bf16 v[4:7], v[144:147], v[132:135], v[4:7]
    ds_read_b128 v[168:171], v197 offset:30720
    v_cvt_pk_bf16_f32 v139, v122, v123
    v_mfma_f32_16x16x32_bf16 v[8:11], v[148:151], v[128:131], v[8:11]
    v_exp_f32 v125, v125
    v_mfma_f32_16x16x32_bf16 v[12:15], v[148:151], v[132:135], v[12:15]
    ds_read_b128 v[172:175], v197 offset:31744
    s_waitcnt lgkmcnt(4)
    v_mfma_f32_16x16x32_bf16 v[184:187], v[192:195], v[128:131], v[184:187]
    v_mfma_f32_16x16x32_bf16 v[16:19], v[152:155], v[128:131], v[16:19]
    v_exp_f32 v126, v126
    v_mfma_f32_16x16x32_bf16 v[20:23], v[152:155], v[132:135], v[20:23]
    s_barrier
    ds_read_b128 v[144:147], v196 offset:0
    v_cvt_pk_bf16_f32 v142, v124, v125
    v_mfma_f32_16x16x32_bf16 v[24:27], v[156:159], v[128:131], v[24:27]
    v_exp_f32 v127, v127
    v_mfma_f32_16x16x32_bf16 v[28:31], v[156:159], v[132:135], v[28:31]
    ds_read_b128 v[148:151], v196 offset:1024
    s_waitcnt lgkmcnt(4)
    v_xor_b32 v197, 0x10000, v197
    v_mfma_f32_16x16x32_bf16 v[32:35], v[160:163], v[128:131], v[32:35]
    v_exp_f32 v96, v96
    v_mfma_f32_16x16x32_bf16 v[36:39], v[160:163], v[132:135], v[36:39]
    ds_read_b128 v[152:155], v196 offset:2048
    v_cvt_pk_bf16_f32 v143, v126, v127
    v_mfma_f32_16x16x32_bf16 v[40:43], v[164:167], v[128:131], v[40:43]
    v_exp_f32 v97, v97
    v_mfma_f32_16x16x32_bf16 v[44:47], v[164:167], v[132:135], v[44:47]
    ds_read_b128 v[156:159], v196 offset:3072
    s_waitcnt lgkmcnt(4)
    v_mfma_f32_16x16x32_bf16 v[188:191], v[192:195], v[132:135], v[188:191]
    v_mfma_f32_16x16x32_bf16 v[48:51], v[168:171], v[128:131], v[48:51]
    v_exp_f32 v98, v98
    v_mfma_f32_16x16x32_bf16 v[52:55], v[168:171], v[132:135], v[52:55]
    ds_read_b128 v[160:163], v196 offset:4096
    v_mfma_f32_16x16x32_bf16 v[56:59], v[172:175], v[128:131], v[56:59]
    v_exp_f32 v99, v99
    v_mfma_f32_16x16x32_bf16 v[60:63], v[172:175], v[132:135], v[60:63]
    ds_read_b128 v[164:167], v196 offset:5120
    v_cvt_pk_bf16_f32 v128, v96, v97
    s_waitcnt lgkmcnt(4)
    s_add_u32 s18, s18, 1
    s_cmp_lt_u32 s18, 15
    s_cbranch_scc1 standalone__kv_cache_quant_pre_rope_vs_post_rope__prompt_kernel_loop
    v_mfma_f32_16x16x32_bf16 v[112:115], v[144:147], v[64:67], v[176:179]
    v_exp_f32 v100, v100
    v_mfma_f32_16x16x32_bf16 v[116:119], v[144:147], v[80:83], v[180:183]
    ds_read_b128 v[168:171], v196 offset:6144
    v_cvt_pk_bf16_f32 v129, v98, v99
    v_mfma_f32_16x16x32_bf16 v[112:115], v[148:151], v[68:71], v[112:115]
    v_exp_f32 v101, v101
    v_mfma_f32_16x16x32_bf16 v[116:119], v[148:151], v[84:87], v[116:119]
    ds_read_b128 v[172:175], v196 offset:7168
    s_waitcnt lgkmcnt(4)
    v_mfma_f32_16x16x32_bf16 v[112:115], v[152:155], v[72:75], v[112:115]
    v_exp_f32 v102, v102
    v_mfma_f32_16x16x32_bf16 v[116:119], v[152:155], v[88:91], v[116:119]
    ds_read_b128 v[144:147], v196 offset:8192
    v_cvt_pk_bf16_f32 v132, v100, v101
    v_mfma_f32_16x16x32_bf16 v[112:115], v[156:159], v[76:79], v[112:115]
    v_exp_f32 v103, v103
    v_mfma_f32_16x16x32_bf16 v[116:119], v[156:159], v[92:95], v[116:119]
    ds_read_b128 v[148:151], v196 offset:9216
    s_waitcnt lgkmcnt(4)
    v_mfma_f32_16x16x32_bf16 v[120:123], v[160:163], v[64:67], v[176:179]
    v_exp_f32 v104, v104
    v_mfma_f32_16x16x32_bf16 v[124:127], v[160:163], v[80:83], v[180:183]
    ds_read_b128 v[152:155], v196 offset:10240
    v_cvt_pk_bf16_f32 v133, v102, v103
    v_mfma_f32_16x16x32_bf16 v[120:123], v[164:167], v[68:71], v[120:123]
    v_exp_f32 v105, v105
    v_mfma_f32_16x16x32_bf16 v[124:127], v[164:167], v[84:87], v[124:127]
    ds_read_b128 v[156:159], v196 offset:11264
    s_waitcnt lgkmcnt(4)
    v_mfma_f32_16x16x32_bf16 v[120:123], v[168:171], v[72:75], v[120:123]
    v_exp_f32 v106, v106
    v_mfma_f32_16x16x32_bf16 v[124:127], v[168:171], v[88:91], v[124:127]
    ds_read_b128 v[160:163], v196 offset:12288
    v_cvt_pk_bf16_f32 v130, v104, v105
    v_mfma_f32_16x16x32_bf16 v[120:123], v[172:175], v[76:79], v[120:123]
    v_exp_f32 v107, v107
    v_mfma_f32_16x16x32_bf16 v[124:127], v[172:175], v[92:95], v[124:127]
    ds_read_b128 v[164:167], v196 offset:13312
    s_waitcnt lgkmcnt(4)
    v_mfma_f32_16x16x32_bf16 v[0:3], v[144:147], v[136:139], v[0:3]
    v_exp_f32 v108, v108
    v_mfma_f32_16x16x32_bf16 v[4:7], v[144:147], v[140:143], v[4:7]
    ds_read_b128 v[168:171], v196 offset:14336
    v_cvt_pk_bf16_f32 v131, v106, v107
    v_mfma_f32_16x16x32_bf16 v[8:11], v[148:151], v[136:139], v[8:11]
    v_exp_f32 v109, v109
    v_mfma_f32_16x16x32_bf16 v[12:15], v[148:151], v[140:143], v[12:15]
    ds_read_b128 v[172:175], v196 offset:15360
    s_waitcnt lgkmcnt(4)
    v_mfma_f32_16x16x32_bf16 v[184:187], v[192:195], v[136:139], v[184:187]
    v_mfma_f32_16x16x32_bf16 v[16:19], v[152:155], v[136:139], v[16:19]
    v_exp_f32 v110, v110
    v_mfma_f32_16x16x32_bf16 v[20:23], v[152:155], v[140:143], v[20:23]
    ds_read_b128 v[144:147], v196 offset:16384
    v_cvt_pk_bf16_f32 v134, v108, v109
    v_mfma_f32_16x16x32_bf16 v[24:27], v[156:159], v[136:139], v[24:27]
    v_exp_f32 v111, v111
    v_mfma_f32_16x16x32_bf16 v[28:31], v[156:159], v[140:143], v[28:31]
    ds_read_b128 v[148:151], v196 offset:17408
    s_waitcnt lgkmcnt(4)
    v_mfma_f32_16x16x32_bf16 v[32:35], v[160:163], v[136:139], v[32:35]
    v_exp_f32 v112, v112
    v_mfma_f32_16x16x32_bf16 v[36:39], v[160:163], v[140:143], v[36:39]
    ds_read_b128 v[152:155], v196 offset:18432
    v_cvt_pk_bf16_f32 v135, v110, v111
    v_mfma_f32_16x16x32_bf16 v[40:43], v[164:167], v[136:139], v[40:43]
    v_exp_f32 v113, v113
    v_mfma_f32_16x16x32_bf16 v[44:47], v[164:167], v[140:143], v[44:47]
    ds_read_b128 v[156:159], v196 offset:19456
    s_waitcnt lgkmcnt(4)
    v_mfma_f32_16x16x32_bf16 v[188:191], v[192:195], v[140:143], v[188:191]
    v_mfma_f32_16x16x32_bf16 v[48:51], v[168:171], v[136:139], v[48:51]
    v_exp_f32 v114, v114
    v_mfma_f32_16x16x32_bf16 v[52:55], v[168:171], v[140:143], v[52:55]
    ds_read_b128 v[160:163], v196 offset:20480
    v_mfma_f32_16x16x32_bf16 v[56:59], v[172:175], v[136:139], v[56:59]
    v_exp_f32 v115, v115
    v_mfma_f32_16x16x32_bf16 v[60:63], v[172:175], v[140:143], v[60:63]
    ds_read_b128 v[164:167], v196 offset:21504
    v_cvt_pk_bf16_f32 v136, v112, v113
    s_waitcnt lgkmcnt(4)
    v_exp_f32 v116, v116
    ds_read_b128 v[168:171], v196 offset:22528
    v_cvt_pk_bf16_f32 v137, v114, v115
    v_exp_f32 v117, v117
    ds_read_b128 v[172:175], v196 offset:23552
    s_waitcnt lgkmcnt(4)
    v_exp_f32 v118, v118
    ds_read_b128 v[144:147], v196 offset:24576
    v_cvt_pk_bf16_f32 v140, v116, v117
    v_exp_f32 v119, v119
    ds_read_b128 v[148:151], v196 offset:25600
    s_waitcnt lgkmcnt(4)
    v_exp_f32 v120, v120
    ds_read_b128 v[152:155], v196 offset:26624
    v_cvt_pk_bf16_f32 v141, v118, v119
    v_exp_f32 v121, v121
    ds_read_b128 v[156:159], v196 offset:27648
    s_waitcnt lgkmcnt(4)
    v_exp_f32 v122, v122
    ds_read_b128 v[160:163], v196 offset:28672
    v_cvt_pk_bf16_f32 v138, v120, v121
    v_exp_f32 v123, v123
    ds_read_b128 v[164:167], v196 offset:29696
    s_waitcnt lgkmcnt(4)
    v_mfma_f32_16x16x32_bf16 v[0:3], v[144:147], v[128:131], v[0:3]
    v_exp_f32 v124, v124
    v_mfma_f32_16x16x32_bf16 v[4:7], v[144:147], v[132:135], v[4:7]
    ds_read_b128 v[168:171], v196 offset:30720
    v_cvt_pk_bf16_f32 v139, v122, v123
    v_mfma_f32_16x16x32_bf16 v[8:11], v[148:151], v[128:131], v[8:11]
    v_exp_f32 v125, v125
    v_mfma_f32_16x16x32_bf16 v[12:15], v[148:151], v[132:135], v[12:15]
    ds_read_b128 v[172:175], v196 offset:31744
    s_waitcnt lgkmcnt(4)
    v_mfma_f32_16x16x32_bf16 v[184:187], v[192:195], v[128:131], v[184:187]
    v_mfma_f32_16x16x32_bf16 v[16:19], v[152:155], v[128:131], v[16:19]
    v_exp_f32 v126, v126
    v_mfma_f32_16x16x32_bf16 v[20:23], v[152:155], v[132:135], v[20:23]
    s_barrier
    ds_read_b128 v[144:147], v197 offset:0
    v_cvt_pk_bf16_f32 v142, v124, v125
    v_mfma_f32_16x16x32_bf16 v[24:27], v[156:159], v[128:131], v[24:27]
    v_exp_f32 v127, v127
    v_mfma_f32_16x16x32_bf16 v[28:31], v[156:159], v[132:135], v[28:31]
    ds_read_b128 v[148:151], v197 offset:1024
    s_waitcnt lgkmcnt(4)
    v_xor_b32 v196, 0x10000, v196
    v_mfma_f32_16x16x32_bf16 v[32:35], v[160:163], v[128:131], v[32:35]
    v_mfma_f32_16x16x32_bf16 v[36:39], v[160:163], v[132:135], v[36:39]
    ds_read_b128 v[152:155], v197 offset:2048
    v_cvt_pk_bf16_f32 v143, v126, v127
    v_mfma_f32_16x16x32_bf16 v[40:43], v[164:167], v[128:131], v[40:43]
    v_mfma_f32_16x16x32_bf16 v[44:47], v[164:167], v[132:135], v[44:47]
    ds_read_b128 v[156:159], v197 offset:3072
    s_waitcnt lgkmcnt(4)
    v_mfma_f32_16x16x32_bf16 v[188:191], v[192:195], v[132:135], v[188:191]
    v_mfma_f32_16x16x32_bf16 v[48:51], v[168:171], v[128:131], v[48:51]
    v_mfma_f32_16x16x32_bf16 v[52:55], v[168:171], v[132:135], v[52:55]
    ds_read_b128 v[160:163], v197 offset:4096
    v_mfma_f32_16x16x32_bf16 v[56:59], v[172:175], v[128:131], v[56:59]
    v_mfma_f32_16x16x32_bf16 v[60:63], v[172:175], v[132:135], v[60:63]
    ds_read_b128 v[164:167], v197 offset:5120
    s_waitcnt lgkmcnt(4)
    ds_read_b128 v[168:171], v197 offset:6144
    ds_read_b128 v[172:175], v197 offset:7168
    s_waitcnt lgkmcnt(4)
    ds_read_b128 v[144:147], v197 offset:8192
    ds_read_b128 v[148:151], v197 offset:9216
    s_waitcnt lgkmcnt(4)
    ds_read_b128 v[152:155], v197 offset:10240
    ds_read_b128 v[156:159], v197 offset:11264
    s_waitcnt lgkmcnt(4)
    ds_read_b128 v[160:163], v197 offset:12288
    ds_read_b128 v[164:167], v197 offset:13312
    s_waitcnt lgkmcnt(4)
    v_mfma_f32_16x16x32_bf16 v[0:3], v[144:147], v[136:139], v[0:3]
    v_mfma_f32_16x16x32_bf16 v[4:7], v[144:147], v[140:143], v[4:7]
    ds_read_b128 v[168:171], v197 offset:14336
    v_mfma_f32_16x16x32_bf16 v[8:11], v[148:151], v[136:139], v[8:11]
    v_mfma_f32_16x16x32_bf16 v[12:15], v[148:151], v[140:143], v[12:15]
    ds_read_b128 v[172:175], v197 offset:15360
    s_waitcnt lgkmcnt(4)
    v_mfma_f32_16x16x32_bf16 v[184:187], v[192:195], v[136:139], v[184:187]
    v_mfma_f32_16x16x32_bf16 v[16:19], v[152:155], v[136:139], v[16:19]
    v_mfma_f32_16x16x32_bf16 v[20:23], v[152:155], v[140:143], v[20:23]
    ds_read_b128 v[144:147], v197 offset:16384
    v_mfma_f32_16x16x32_bf16 v[24:27], v[156:159], v[136:139], v[24:27]
    v_mfma_f32_16x16x32_bf16 v[28:31], v[156:159], v[140:143], v[28:31]
    ds_read_b128 v[148:151], v197 offset:17408
    s_waitcnt lgkmcnt(4)
    v_mfma_f32_16x16x32_bf16 v[32:35], v[160:163], v[136:139], v[32:35]
    v_mfma_f32_16x16x32_bf16 v[36:39], v[160:163], v[140:143], v[36:39]
    ds_read_b128 v[152:155], v197 offset:18432
    v_mfma_f32_16x16x32_bf16 v[40:43], v[164:167], v[136:139], v[40:43]
    v_mfma_f32_16x16x32_bf16 v[44:47], v[164:167], v[140:143], v[44:47]
    ds_read_b128 v[156:159], v197 offset:19456
    s_waitcnt lgkmcnt(4)
    v_mfma_f32_16x16x32_bf16 v[188:191], v[192:195], v[140:143], v[188:191]
    v_mfma_f32_16x16x32_bf16 v[48:51], v[168:171], v[136:139], v[48:51]
    v_mfma_f32_16x16x32_bf16 v[52:55], v[168:171], v[140:143], v[52:55]
    ds_read_b128 v[160:163], v197 offset:20480
    v_mfma_f32_16x16x32_bf16 v[56:59], v[172:175], v[136:139], v[56:59]
    v_mfma_f32_16x16x32_bf16 v[60:63], v[172:175], v[140:143], v[60:63]
    ds_read_b128 v[164:167], v197 offset:21504
    s_waitcnt lgkmcnt(4)
    s_waitcnt lgkmcnt(0)
    s_nop 7
    v_rcp_f32 v202, v184
    v_rcp_f32 v203, v188
    v_cmp_le_f32 vcc, 0x2b800000, v184
    s_nop 3
    s_mov_b64 s[30:31], vcc
    v_cmp_ge_f32 vcc, 0x53800000, v184
    s_nop 3
    s_and_b64 s[30:31], s[30:31], vcc
    v_cmp_le_f32 vcc, 0x2b800000, v188
    s_nop 3
    s_and_b64 s[30:31], s[30:31], vcc
    v_cmp_ge_f32 vcc, 0x53800000, v188
    s_nop 3
    s_and_b64 s[30:31], s[30:31], vcc
    v_lshrrev_b32 v152, 4, v199
    s_lshl_b32 s29, s20, 13
    s_add_u32 s29, s29, 0x18000
    v_and_b32 v153, 15, v152
    v_lshrrev_b32 v154, 4, v152
    v_lshlrev_b32 v155, 1, v154
    v_xor_b32 v155, v155, v153
    v_lshlrev_b32 v155, 4, v155
    v_lshl_add_u32 v144, v153, 8, v155
    v_add_u32 v144, s29, v144
    v_xor_b32 v145, 0x10, v144
    v_xor_b32 v146, 0x80, v144
    v_xor_b32 v147, 0x90, v144
    v_xor_b32 v155, v153, v154
    v_lshlrev_b32 v155, 4, v155
    v_lshl_add_u32 v148, v154, 8, v155
    v_add_u32 v148, s29, v148
    v_xor_b32 v149, 0x40, v148
    v_xor_b32 v150, 0x80, v148
    v_xor_b32 v151, 0xc0, v148
    v_add_u32 v152, 0x1000, v199
    v_mul_f32 v0, v0, v202
    v_mul_f32 v1, v1, v202
    v_mul_f32 v2, v2, v202
    v_mul_f32 v3, v3, v202
    v_mul_f32 v8, v8, v202
    v_mul_f32 v9, v9, v202
    v_mul_f32 v10, v10, v202
    v_mul_f32 v11, v11, v202
    v_mul_f32 v16, v16, v202
    v_mul_f32 v17, v17, v202
    v_mul_f32 v18, v18, v202
    v_mul_f32 v19, v19, v202
    v_mul_f32 v24, v24, v202
    v_mul_f32 v25, v25, v202
    v_mul_f32 v26, v26, v202
    v_mul_f32 v27, v27, v202
    v_cvt_pk_bf16_f32 v96, v0, v8
    v_cvt_pk_bf16_f32 v97, v16, v24
    v_cvt_pk_bf16_f32 v98, v1, v9
    v_cvt_pk_bf16_f32 v99, v17, v25
    v_cvt_pk_bf16_f32 v100, v2, v10
    v_cvt_pk_bf16_f32 v101, v18, v26
    v_cvt_pk_bf16_f32 v102, v3, v11
    v_cvt_pk_bf16_f32 v103, v19, v27
    ds_write_b128 v144, v[96:99] offset:0
    ds_write_b128 v145, v[100:103] offset:0
    v_mul_f32 v32, v32, v202
    v_mul_f32 v33, v33, v202
    v_mul_f32 v34, v34, v202
    v_mul_f32 v35, v35, v202
    v_mul_f32 v40, v40, v202
    v_mul_f32 v41, v41, v202
    v_mul_f32 v42, v42, v202
    v_mul_f32 v43, v43, v202
    v_mul_f32 v48, v48, v202
    v_mul_f32 v49, v49, v202
    v_mul_f32 v50, v50, v202
    v_mul_f32 v51, v51, v202
    v_mul_f32 v56, v56, v202
    v_mul_f32 v57, v57, v202
    v_mul_f32 v58, v58, v202
    v_mul_f32 v59, v59, v202
    v_cvt_pk_bf16_f32 v104, v32, v40
    v_cvt_pk_bf16_f32 v105, v48, v56
    v_cvt_pk_bf16_f32 v106, v33, v41
    v_cvt_pk_bf16_f32 v107, v49, v57
    v_cvt_pk_bf16_f32 v108, v34, v42
    v_cvt_pk_bf16_f32 v109, v50, v58
    v_cvt_pk_bf16_f32 v110, v35, v43
    v_cvt_pk_bf16_f32 v111, v51, v59
    ds_write_b128 v146, v[104:107] offset:0
    ds_write_b128 v147, v[108:111] offset:0
    v_mul_f32 v4, v4, v203
    v_mul_f32 v5, v5, v203
    v_mul_f32 v6, v6, v203
    v_mul_f32 v7, v7, v203
    v_mul_f32 v12, v12, v203
    v_mul_f32 v13, v13, v203
    v_mul_f32 v14, v14, v203
    v_mul_f32 v15, v15, v203
    v_mul_f32 v20, v20, v203
    v_mul_f32 v21, v21, v203
    v_mul_f32 v22, v22, v203
    v_mul_f32 v23, v23, v203
    v_mul_f32 v28, v28, v203
    v_mul_f32 v29, v29, v203
    v_mul_f32 v30, v30, v203
    v_mul_f32 v31, v31, v203
    v_cvt_pk_bf16_f32 v112, v4, v12
    v_cvt_pk_bf16_f32 v113, v20, v28
    v_cvt_pk_bf16_f32 v114, v5, v13
    v_cvt_pk_bf16_f32 v115, v21, v29
    v_cvt_pk_bf16_f32 v116, v6, v14
    v_cvt_pk_bf16_f32 v117, v22, v30
    v_cvt_pk_bf16_f32 v118, v7, v15
    v_cvt_pk_bf16_f32 v119, v23, v31
    ds_write_b128 v144, v[112:115] offset:4096
    ds_write_b128 v145, v[116:119] offset:4096
    v_mul_f32 v36, v36, v203
    v_mul_f32 v37, v37, v203
    v_mul_f32 v38, v38, v203
    v_mul_f32 v39, v39, v203
    v_mul_f32 v44, v44, v203
    v_mul_f32 v45, v45, v203
    v_mul_f32 v46, v46, v203
    v_mul_f32 v47, v47, v203
    v_mul_f32 v52, v52, v203
    v_mul_f32 v53, v53, v203
    v_mul_f32 v54, v54, v203
    v_mul_f32 v55, v55, v203
    v_mul_f32 v60, v60, v203
    v_mul_f32 v61, v61, v203
    v_mul_f32 v62, v62, v203
    v_mul_f32 v63, v63, v203
    v_cvt_pk_bf16_f32 v120, v36, v44
    v_cvt_pk_bf16_f32 v121, v52, v60
    v_cvt_pk_bf16_f32 v122, v37, v45
    v_cvt_pk_bf16_f32 v123, v53, v61
    v_cvt_pk_bf16_f32 v124, v38, v46
    v_cvt_pk_bf16_f32 v125, v54, v62
    v_cvt_pk_bf16_f32 v126, v39, v47
    v_cvt_pk_bf16_f32 v127, v55, v63
    ds_write_b128 v146, v[120:123] offset:4096
    ds_write_b128 v147, v[124:127] offset:4096
    s_waitcnt lgkmcnt(0)
    ds_read_b128 v[96:99], v148 offset:0
    ds_read_b128 v[100:103], v149 offset:1024
    ds_read_b128 v[104:107], v150 offset:2048
    ds_read_b128 v[108:111], v151 offset:3072
    ds_read_b128 v[112:115], v148 offset:4096
    ds_read_b128 v[116:119], v149 offset:5120
    ds_read_b128 v[120:123], v150 offset:6144
    ds_read_b128 v[124:127], v151 offset:7168
    s_waitcnt lgkmcnt(7)
    buffer_store_dwordx4 v[96:99], v199, s[80:83], 0 offen offset:0
    s_waitcnt lgkmcnt(6)
    buffer_store_dwordx4 v[100:103], v199, s[80:83], 0 offen offset:1024
    s_waitcnt lgkmcnt(5)
    buffer_store_dwordx4 v[104:107], v199, s[80:83], 0 offen offset:2048
    s_waitcnt lgkmcnt(4)
    buffer_store_dwordx4 v[108:111], v199, s[80:83], 0 offen offset:3072
    s_waitcnt lgkmcnt(3)
    buffer_store_dwordx4 v[112:115], v152, s[80:83], 0 offen offset:0
    s_waitcnt lgkmcnt(2)
    buffer_store_dwordx4 v[116:119], v152, s[80:83], 0 offen offset:1024
    s_waitcnt lgkmcnt(1)
    buffer_store_dwordx4 v[120:123], v152, s[80:83], 0 offen offset:2048
    s_waitcnt lgkmcnt(0)
    buffer_store_dwordx4 v[124:127], v152, s[80:83], 0 offen offset:3072
    s_cmp_eq_u64 s[30:31], -1
    s_cbranch_scc1 standalone__kv_cache_quant_pre_rope_vs_post_rope__prompt_kernel_safe
    v_mov_b32 v200, 1
    v_mov_b32 v201, 131072
    ds_write_b32 v201, v200
standalone__kv_cache_quant_pre_rope_vs_post_rope__prompt_kernel_safe:
    s_waitcnt lgkmcnt(0)
    s_barrier
    s_cmp_lg_u32 s19, 0
    s_cbranch_scc1 standalone__kv_cache_quant_pre_rope_vs_post_rope__prompt_kernel_done
    v_mov_b32 v201, 131072
    ds_read_b32 v200, v201
    s_waitcnt lgkmcnt(0)
    v_readfirstlane_b32 s18, v200
    s_cmp_eq_u32 s18, 0
    s_cbranch_scc1 standalone__kv_cache_quant_pre_rope_vs_post_rope__prompt_kernel_done
    s_mov_b32 s19, 1
    v_mov_b32 v202, 0xff800000
    v_mov_b32 v203, 0xff800000
    s_mov_b32 s18, 0
standalone__kv_cache_quant_pre_rope_vs_post_rope__prompt_kernel_maxloop:
    s_lshr_b32 s16, s18, 1
    s_lshl_b32 s16, s16, 15
    s_and_b32 s17, s18, 1
    s_lshl_b32 s17, s17, 13
    s_add_u32 s16, s16, s17
    s_add_u32 s17, s16, 4096
    buffer_load_dwordx4 v[144:147], v199, s[24:27], s16 offen offset:0 sc1
    buffer_load_dwordx4 v[148:151], v199, s[24:27], s16 offen offset:1024 sc1
    buffer_load_dwordx4 v[152:155], v199, s[24:27], s16 offen offset:2048 sc1
    buffer_load_dwordx4 v[156:159], v199, s[24:27], s16 offen offset:3072 sc1
    buffer_load_dwordx4 v[160:163], v199, s[24:27], s17 offen offset:0 sc1
    buffer_load_dwordx4 v[164:167], v199, s[24:27], s17 offen offset:1024 sc1
    buffer_load_dwordx4 v[168:171], v199, s[24:27], s17 offen offset:2048 sc1
    buffer_load_dwordx4 v[172:175], v199, s[24:27], s17 offen offset:3072 sc1
    s_waitcnt vmcnt(0)
    v_mfma_f32_16x16x32_bf16 v[96:99], v[144:147], v[64:67], 0
    v_mfma_f32_16x16x32_bf16 v[100:103], v[144:147], v[80:83], 0
    v_mfma_f32_16x16x32_bf16 v[96:99], v[148:151], v[68:71], v[96:99]
    v_mfma_f32_16x16x32_bf16 v[100:103], v[148:151], v[84:87], v[100:103]
    v_mfma_f32_16x16x32_bf16 v[96:99], v[152:155], v[72:75], v[96:99]
    v_mfma_f32_16x16x32_bf16 v[100:103], v[152:155], v[88:91], v[100:103]
    v_mfma_f32_16x16x32_bf16 v[96:99], v[156:159], v[76:79], v[96:99]
    v_mfma_f32_16x16x32_bf16 v[100:103], v[156:159], v[92:95], v[100:103]
    v_mfma_f32_16x16x32_bf16 v[104:107], v[160:163], v[64:67], 0
    v_mfma_f32_16x16x32_bf16 v[108:111], v[160:163], v[80:83], 0
    v_mfma_f32_16x16x32_bf16 v[104:107], v[164:167], v[68:71], v[104:107]
    v_mfma_f32_16x16x32_bf16 v[108:111], v[164:167], v[84:87], v[108:111]
    v_mfma_f32_16x16x32_bf16 v[104:107], v[168:171], v[72:75], v[104:107]
    v_mfma_f32_16x16x32_bf16 v[108:111], v[168:171], v[88:91], v[108:111]
    v_mfma_f32_16x16x32_bf16 v[104:107], v[172:175], v[76:79], v[104:107]
    v_mfma_f32_16x16x32_bf16 v[108:111], v[172:175], v[92:95], v[108:111]
    s_nop 15
    v_max_f32 v202, v202, v96
    v_max_f32 v202, v202, v97
    v_max_f32 v202, v202, v98
    v_max_f32 v202, v202, v99
    v_max_f32 v203, v203, v100
    v_max_f32 v203, v203, v101
    v_max_f32 v203, v203, v102
    v_max_f32 v203, v203, v103
    v_max_f32 v202, v202, v104
    v_max_f32 v202, v202, v105
    v_max_f32 v202, v202, v106
    v_max_f32 v202, v202, v107
    v_max_f32 v203, v203, v108
    v_max_f32 v203, v203, v109
    v_max_f32 v203, v203, v110
    v_max_f32 v203, v203, v111
    s_add_u32 s18, s18, 1
    s_cmp_lt_u32 s18, 64
    s_cbranch_scc1 standalone__kv_cache_quant_pre_rope_vs_post_rope__prompt_kernel_maxloop
    v_mov_b32 v204, v202
    s_nop 1
    v_permlane32_swap_b32 v202, v204
    s_nop 1
    v_max_f32 v202, v202, v204
    v_mov_b32 v204, v202
    s_nop 1
    v_permlane16_swap_b32 v202, v204
    s_nop 1
    v_max_f32 v202, v202, v204
    v_sub_f32 v176, 0, v202
    v_sub_f32 v177, 0, v202
    v_sub_f32 v178, 0, v202
    v_sub_f32 v179, 0, v202
    v_mov_b32 v204, v203
    s_nop 1
    v_permlane32_swap_b32 v203, v204
    s_nop 1
    v_max_f32 v203, v203, v204
    v_mov_b32 v204, v203
    s_nop 1
    v_permlane16_swap_b32 v203, v204
    s_nop 1
    v_max_f32 v203, v203, v204
    v_sub_f32 v180, 0, v203
    v_sub_f32 v181, 0, v203
    v_sub_f32 v182, 0, v203
    v_sub_f32 v183, 0, v203
    s_branch standalone__kv_cache_quant_pre_rope_vs_post_rope__prompt_kernel_main
standalone__kv_cache_quant_pre_rope_vs_post_rope__prompt_kernel_done:
    s_endpgm
standalone__kv_cache_quant_pre_rope_vs_post_rope__prompt_kernel_helper:
    s_cmp_eq_u32 s20, 4
    s_cbranch_scc1 standalone__kv_cache_quant_pre_rope_vs_post_rope__prompt_kernel_loader
    s_cmp_eq_u32 s20, 5
    s_cbranch_scc0 standalone__kv_cache_quant_pre_rope_vs_post_rope__prompt_kernel_nopub
    s_cmp_eq_u32 s22, 0
    s_cbranch_scc0 standalone__kv_cache_quant_pre_rope_vs_post_rope__prompt_kernel_nopub
    s_memrealtime s[30:31]
    s_waitcnt lgkmcnt(0)
    s_lshl_b32 s30, s30, 4
    s_or_b32 s30, s30, 1
    v_mov_b32 v10, s30
    v_mov_b32 v11, s41
    global_store_dword v11, v10, s[68:69] sc0 sc1
standalone__kv_cache_quant_pre_rope_vs_post_rope__prompt_kernel_nopub:
    s_sub_u32 s43, s20, 5
    s_mul_i32 s84, s22, 3
    s_add_u32 s84, s84, s43
    s_lshl_b32 s84, s84, 2
    s_cmp_eq_u32 s20, 7
    s_cbranch_scc1 standalone__kv_cache_quant_pre_rope_vs_post_rope__prompt_kernel_prodv
    v_and_b32 v3, 7, v2
    v_lshrrev_b32 v4, 3, v2
    v_lshlrev_b32 v5, 9, v4
    v_lshl_add_u32 v5, v3, 5, v5
    v_lshlrev_b32 v6, 8, v4
    v_lshl_add_u32 v6, v3, 4, v6
    v_lshlrev_b32 v7, 1, v4
    v_lshl_add_u32 v14, v3, 3, v4
    v_lshlrev_b32 v14, 2, v14
    v_lshrrev_b32 v8, 2, v4
    v_lshlrev_b32 v8, 11, v8
    v_and_b32 v9, 3, v4
    v_lshl_add_u32 v8, v9, 8, v8
    v_lshl_add_u32 v8, v3, 4, v8
    s_add_u32 s4, s46, s23
    s_addc_u32 s5, s47, 0
    s_mov_b32 s6, 0x100000
    s_mov_b32 s7, 0x20000
    s_mov_b32 s8, s62
    s_mov_b32 s9, s63
    s_mov_b32 s10, 0x80000
    s_mov_b32 s11, 0x20000
    s_mov_b32 s12, s64
    s_mov_b32 s13, s65
    s_mov_b32 s14, 0x80000
    s_mov_b32 s15, 0x20000
    s_lshl_b32 s28, s21, 12
    s_add_u32 s32, s48, s28
    s_addc_u32 s33, s49, 0
    s_mov_b32 s34, 0x1000
    s_mov_b32 s35, 0x20000
    s_add_u32 s36, s50, s28
    s_addc_u32 s37, s51, 0
    s_mov_b32 s38, 0x1000
    s_mov_b32 s39, 0x20000
    s_lshl_b32 s28, s22, 4
    s_lshl_b32 s29, s43, 3
    s_add_u32 s28, s28, s29
    s_lshl_b32 s87, s28, 9
    s_lshl_b32 s88, s28, 8
    s_lshl_b32 s89, s28, 1
    s_lshr_b32 s90, s22, 2
    s_lshl_b32 s90, s90, 15
    s_bfe_u32 s29, s22, 0x10001
    s_lshl_b32 s29, s29, 13
    s_add_u32 s90, s90, s29
    s_and_b32 s29, s22, 1
    s_lshl_b32 s29, s29, 12
    s_add_u32 s90, s90, s29
    s_lshl_b32 s29, s43, 7
    s_add_u32 s90, s90, s29
    buffer_load_ushort v48, v7, s[32:35], s89 offen
    buffer_load_ushort v49, v7, s[36:39], s89 offen
    buffer_load_dwordx4 v[16:19], v5, s[4:7], s87 offen offset:0 nt
    buffer_load_dwordx4 v[20:23], v5, s[4:7], s87 offen offset:16 nt
    buffer_load_dwordx4 v[24:27], v5, s[4:7], s87 offen offset:256 nt
    buffer_load_dwordx4 v[28:31], v5, s[4:7], s87 offen offset:272 nt
    buffer_load_dwordx4 v[32:35], v6, s[8:11], s88 offen offset:0
    buffer_load_dwordx4 v[36:39], v6, s[8:11], s88 offen offset:128
    buffer_load_dwordx4 v[40:43], v6, s[12:15], s88 offen offset:0
    buffer_load_dwordx4 v[44:47], v6, s[12:15], s88 offen offset:128
    s_add_u32 s87, s87, 0x20000
    s_add_u32 s88, s88, 0x10000
    s_add_u32 s89, s89, 512
    s_waitcnt vmcnt(0)
    s_barrier
    v_lshlrev_b32 v88, 16, v48
    v_lshlrev_b32 v89, 16, v49
    v_mul_f32 v88, 0x3e0293ee, v88
    v_cvt_f32_i32 v16, v16
    v_cvt_f32_i32 v17, v17
    v_cvt_f32_i32 v18, v18
    v_cvt_f32_i32 v19, v19
    v_cvt_f32_i32 v20, v20
    v_cvt_f32_i32 v21, v21
    v_cvt_f32_i32 v22, v22
    v_cvt_f32_i32 v23, v23
    v_cvt_f32_i32 v24, v24
    v_cvt_f32_i32 v25, v25
    v_cvt_f32_i32 v26, v26
    v_cvt_f32_i32 v27, v27
    v_cvt_f32_i32 v28, v28
    v_cvt_f32_i32 v29, v29
    v_cvt_f32_i32 v30, v30
    v_cvt_f32_i32 v31, v31
    v_mul_f32 v89, v89, v88
    v_fma_f32 v16, v16, v88, -v89
    v_fma_f32 v17, v17, v88, -v89
    v_fma_f32 v18, v18, v88, -v89
    v_fma_f32 v19, v19, v88, -v89
    v_fma_f32 v20, v20, v88, -v89
    v_fma_f32 v21, v21, v88, -v89
    v_fma_f32 v22, v22, v88, -v89
    v_fma_f32 v23, v23, v88, -v89
    v_fma_f32 v24, v24, v88, -v89
    v_fma_f32 v25, v25, v88, -v89
    v_fma_f32 v26, v26, v88, -v89
    v_fma_f32 v27, v27, v88, -v89
    v_fma_f32 v28, v28, v88, -v89
    v_fma_f32 v29, v29, v88, -v89
    v_fma_f32 v30, v30, v88, -v89
    v_fma_f32 v31, v31, v88, -v89
    v_lshlrev_b32 v90, 16, v32
    v_lshlrev_b32 v91, 16, v36
    v_lshlrev_b32 v92, 16, v40
    v_lshlrev_b32 v93, 16, v44
    v_mul_f32 v92, v24, v92
    v_mul_f32 v93, v16, v93
    v_fma_f32 v94, v16, v90, -v92
    v_fma_f32 v96, v24, v91, v93
    v_and_b32 v90, 0xffff0000, v32
    v_and_b32 v91, 0xffff0000, v36
    v_and_b32 v92, 0xffff0000, v40
    v_and_b32 v93, 0xffff0000, v44
    v_mul_f32 v92, v25, v92
    v_mul_f32 v93, v17, v93
    v_fma_f32 v95, v17, v90, -v92
    v_fma_f32 v97, v25, v91, v93
    v_cvt_pk_bf16_f32 v104, v94, v95
    v_cvt_pk_bf16_f32 v106, v96, v97
    v_lshlrev_b32 v90, 16, v33
    v_lshlrev_b32 v91, 16, v37
    v_lshlrev_b32 v92, 16, v41
    v_lshlrev_b32 v93, 16, v45
    v_mul_f32 v92, v26, v92
    v_mul_f32 v93, v18, v93
    v_fma_f32 v94, v18, v90, -v92
    v_fma_f32 v96, v26, v91, v93
    v_and_b32 v90, 0xffff0000, v33
    v_and_b32 v91, 0xffff0000, v37
    v_and_b32 v92, 0xffff0000, v41
    v_and_b32 v93, 0xffff0000, v45
    v_mul_f32 v92, v27, v92
    v_mul_f32 v93, v19, v93
    v_fma_f32 v95, v19, v90, -v92
    v_fma_f32 v97, v27, v91, v93
    v_cvt_pk_bf16_f32 v105, v94, v95
    v_cvt_pk_bf16_f32 v107, v96, v97
    v_lshlrev_b32 v90, 16, v34
    v_lshlrev_b32 v91, 16, v38
    v_lshlrev_b32 v92, 16, v42
    v_lshlrev_b32 v93, 16, v46
    v_mul_f32 v92, v28, v92
    v_mul_f32 v93, v20, v93
    v_fma_f32 v94, v20, v90, -v92
    v_fma_f32 v96, v28, v91, v93
    v_and_b32 v90, 0xffff0000, v34
    v_and_b32 v91, 0xffff0000, v38
    v_and_b32 v92, 0xffff0000, v42
    v_and_b32 v93, 0xffff0000, v46
    v_mul_f32 v92, v29, v92
    v_mul_f32 v93, v21, v93
    v_fma_f32 v95, v21, v90, -v92
    v_fma_f32 v97, v29, v91, v93
    v_cvt_pk_bf16_f32 v108, v94, v95
    v_cvt_pk_bf16_f32 v110, v96, v97
    v_lshlrev_b32 v90, 16, v35
    v_lshlrev_b32 v91, 16, v39
    v_lshlrev_b32 v92, 16, v43
    v_lshlrev_b32 v93, 16, v47
    v_mul_f32 v92, v30, v92
    v_mul_f32 v93, v22, v93
    v_fma_f32 v94, v22, v90, -v92
    v_fma_f32 v96, v30, v91, v93
    v_and_b32 v90, 0xffff0000, v35
    v_and_b32 v91, 0xffff0000, v39
    v_and_b32 v92, 0xffff0000, v43
    v_and_b32 v93, 0xffff0000, v47
    v_mul_f32 v92, v31, v92
    v_mul_f32 v93, v23, v93
    v_fma_f32 v95, v23, v90, -v92
    v_fma_f32 v97, v31, v91, v93
    v_cvt_pk_bf16_f32 v109, v94, v95
    v_cvt_pk_bf16_f32 v111, v96, v97
    ds_bpermute_b32 v104, v14, v104
    ds_bpermute_b32 v105, v14, v105
    ds_bpermute_b32 v106, v14, v106
    ds_bpermute_b32 v107, v14, v107
    ds_bpermute_b32 v108, v14, v108
    ds_bpermute_b32 v109, v14, v109
    ds_bpermute_b32 v110, v14, v110
    ds_bpermute_b32 v111, v14, v111
    s_waitcnt lgkmcnt(0)
    buffer_store_dwordx4 v[104:107], v8, s[24:27], s90 offen offset:0 sc0 sc1
    buffer_store_dwordx4 v[108:111], v8, s[24:27], s90 offen offset:1024 sc0 sc1
    s_add_u32 s90, s90, 0x20000
    v_mov_b32 v12, s41
    global_load_dword v13, v12, s[68:69] sc1
    s_waitcnt vmcnt(0)
    v_readfirstlane_b32 s40, v13
    s_cmp_lg_u32 s40, 0
    s_cbranch_scc1 standalone__kv_cache_quant_pre_rope_vs_post_rope__prompt_kernel_k_gotn
standalone__kv_cache_quant_pre_rope_vs_post_rope__prompt_kernel_k_npoll:
    v_mov_b32 v12, s41
    global_load_dword v13, v12, s[68:69] sc1
    s_waitcnt vmcnt(0)
    v_readfirstlane_b32 s40, v13
    s_cmp_eq_u32 s40, 0
    s_cbranch_scc1 standalone__kv_cache_quant_pre_rope_vs_post_rope__prompt_kernel_k_npoll
    s_and_b32 s40, s40, 0xfffffff0
standalone__kv_cache_quant_pre_rope_vs_post_rope__prompt_kernel_k_gotn:
    s_and_b32 s40, s40, 0xfffffff0
    s_add_u32 s85, s40, 1
    v_mov_b32 v10, s85
    v_mov_b32 v11, s84
    s_mov_b64 exec, 1
    buffer_store_dword v10, v11, s[72:75], 0 offen sc0 sc1
    s_mov_b64 exec, -1
    buffer_load_ushort v84, v7, s[32:35], s89 offen
    buffer_load_ushort v85, v7, s[36:39], s89 offen
    buffer_load_dwordx4 v[52:55], v5, s[4:7], s87 offen offset:0 nt
    buffer_load_dwordx4 v[56:59], v5, s[4:7], s87 offen offset:16 nt
    buffer_load_dwordx4 v[60:63], v5, s[4:7], s87 offen offset:256 nt
    buffer_load_dwordx4 v[64:67], v5, s[4:7], s87 offen offset:272 nt
    buffer_load_dwordx4 v[68:71], v6, s[8:11], s88 offen offset:0
    buffer_load_dwordx4 v[72:75], v6, s[8:11], s88 offen offset:128
    buffer_load_dwordx4 v[76:79], v6, s[12:15], s88 offen offset:0
    buffer_load_dwordx4 v[80:83], v6, s[12:15], s88 offen offset:128
    s_add_u32 s87, s87, 0x20000
    s_add_u32 s88, s88, 0x10000
    s_add_u32 s89, s89, 512
    s_barrier
    s_waitcnt vmcnt(0)
    v_lshlrev_b32 v88, 16, v84
    v_lshlrev_b32 v89, 16, v85
    v_mul_f32 v88, 0x3e0293ee, v88
    v_cvt_f32_i32 v52, v52
    v_cvt_f32_i32 v53, v53
    v_cvt_f32_i32 v54, v54
    v_cvt_f32_i32 v55, v55
    v_cvt_f32_i32 v56, v56
    v_cvt_f32_i32 v57, v57
    v_cvt_f32_i32 v58, v58
    v_cvt_f32_i32 v59, v59
    v_cvt_f32_i32 v60, v60
    v_cvt_f32_i32 v61, v61
    v_cvt_f32_i32 v62, v62
    v_cvt_f32_i32 v63, v63
    v_cvt_f32_i32 v64, v64
    v_cvt_f32_i32 v65, v65
    v_cvt_f32_i32 v66, v66
    v_cvt_f32_i32 v67, v67
    v_mul_f32 v89, v89, v88
    v_fma_f32 v52, v52, v88, -v89
    v_fma_f32 v53, v53, v88, -v89
    v_fma_f32 v54, v54, v88, -v89
    v_fma_f32 v55, v55, v88, -v89
    v_fma_f32 v56, v56, v88, -v89
    v_fma_f32 v57, v57, v88, -v89
    v_fma_f32 v58, v58, v88, -v89
    v_fma_f32 v59, v59, v88, -v89
    v_fma_f32 v60, v60, v88, -v89
    v_fma_f32 v61, v61, v88, -v89
    v_fma_f32 v62, v62, v88, -v89
    v_fma_f32 v63, v63, v88, -v89
    v_fma_f32 v64, v64, v88, -v89
    v_fma_f32 v65, v65, v88, -v89
    v_fma_f32 v66, v66, v88, -v89
    v_fma_f32 v67, v67, v88, -v89
    v_lshlrev_b32 v90, 16, v68
    v_lshlrev_b32 v91, 16, v72
    v_lshlrev_b32 v92, 16, v76
    v_lshlrev_b32 v93, 16, v80
    v_mul_f32 v92, v60, v92
    v_mul_f32 v93, v52, v93
    v_fma_f32 v94, v52, v90, -v92
    v_fma_f32 v96, v60, v91, v93
    v_and_b32 v90, 0xffff0000, v68
    v_and_b32 v91, 0xffff0000, v72
    v_and_b32 v92, 0xffff0000, v76
    v_and_b32 v93, 0xffff0000, v80
    v_mul_f32 v92, v61, v92
    v_mul_f32 v93, v53, v93
    v_fma_f32 v95, v53, v90, -v92
    v_fma_f32 v97, v61, v91, v93
    v_cvt_pk_bf16_f32 v112, v94, v95
    v_cvt_pk_bf16_f32 v114, v96, v97
    v_lshlrev_b32 v90, 16, v69
    v_lshlrev_b32 v91, 16, v73
    v_lshlrev_b32 v92, 16, v77
    v_lshlrev_b32 v93, 16, v81
    v_mul_f32 v92, v62, v92
    v_mul_f32 v93, v54, v93
    v_fma_f32 v94, v54, v90, -v92
    v_fma_f32 v96, v62, v91, v93
    v_and_b32 v90, 0xffff0000, v69
    v_and_b32 v91, 0xffff0000, v73
    v_and_b32 v92, 0xffff0000, v77
    v_and_b32 v93, 0xffff0000, v81
    v_mul_f32 v92, v63, v92
    v_mul_f32 v93, v55, v93
    v_fma_f32 v95, v55, v90, -v92
    v_fma_f32 v97, v63, v91, v93
    v_cvt_pk_bf16_f32 v113, v94, v95
    v_cvt_pk_bf16_f32 v115, v96, v97
    v_lshlrev_b32 v90, 16, v70
    v_lshlrev_b32 v91, 16, v74
    v_lshlrev_b32 v92, 16, v78
    v_lshlrev_b32 v93, 16, v82
    v_mul_f32 v92, v64, v92
    v_mul_f32 v93, v56, v93
    v_fma_f32 v94, v56, v90, -v92
    v_fma_f32 v96, v64, v91, v93
    v_and_b32 v90, 0xffff0000, v70
    v_and_b32 v91, 0xffff0000, v74
    v_and_b32 v92, 0xffff0000, v78
    v_and_b32 v93, 0xffff0000, v82
    v_mul_f32 v92, v65, v92
    v_mul_f32 v93, v57, v93
    v_fma_f32 v95, v57, v90, -v92
    v_fma_f32 v97, v65, v91, v93
    v_cvt_pk_bf16_f32 v116, v94, v95
    v_cvt_pk_bf16_f32 v118, v96, v97
    v_lshlrev_b32 v90, 16, v71
    v_lshlrev_b32 v91, 16, v75
    v_lshlrev_b32 v92, 16, v79
    v_lshlrev_b32 v93, 16, v83
    v_mul_f32 v92, v66, v92
    v_mul_f32 v93, v58, v93
    v_fma_f32 v94, v58, v90, -v92
    v_fma_f32 v96, v66, v91, v93
    v_and_b32 v90, 0xffff0000, v71
    v_and_b32 v91, 0xffff0000, v75
    v_and_b32 v92, 0xffff0000, v79
    v_and_b32 v93, 0xffff0000, v83
    v_mul_f32 v92, v67, v92
    v_mul_f32 v93, v59, v93
    v_fma_f32 v95, v59, v90, -v92
    v_fma_f32 v97, v67, v91, v93
    v_cvt_pk_bf16_f32 v117, v94, v95
    v_cvt_pk_bf16_f32 v119, v96, v97
    ds_bpermute_b32 v112, v14, v112
    ds_bpermute_b32 v113, v14, v113
    ds_bpermute_b32 v114, v14, v114
    ds_bpermute_b32 v115, v14, v115
    ds_bpermute_b32 v116, v14, v116
    ds_bpermute_b32 v117, v14, v117
    ds_bpermute_b32 v118, v14, v118
    ds_bpermute_b32 v119, v14, v119
    s_waitcnt lgkmcnt(0)
    buffer_store_dwordx4 v[112:115], v8, s[24:27], s90 offen offset:0 sc0 sc1
    buffer_store_dwordx4 v[116:119], v8, s[24:27], s90 offen offset:1024 sc0 sc1
    s_add_u32 s90, s90, 0x20000
    s_waitcnt vmcnt(0)
    s_add_u32 s85, s40, 2
    v_mov_b32 v10, s85
    v_mov_b32 v11, s84
    s_mov_b64 exec, 1
    buffer_store_dword v10, v11, s[72:75], 0 offen sc0 sc1
    s_mov_b64 exec, -1
    s_setprio 0
    buffer_load_ushort v48, v7, s[32:35], s89 offen
    buffer_load_ushort v49, v7, s[36:39], s89 offen
    buffer_load_dwordx4 v[16:19], v5, s[4:7], s87 offen offset:0 nt
    buffer_load_dwordx4 v[20:23], v5, s[4:7], s87 offen offset:16 nt
    buffer_load_dwordx4 v[24:27], v5, s[4:7], s87 offen offset:256 nt
    buffer_load_dwordx4 v[28:31], v5, s[4:7], s87 offen offset:272 nt
    buffer_load_dwordx4 v[32:35], v6, s[8:11], s88 offen offset:0
    buffer_load_dwordx4 v[36:39], v6, s[8:11], s88 offen offset:128
    buffer_load_dwordx4 v[40:43], v6, s[12:15], s88 offen offset:0
    buffer_load_dwordx4 v[44:47], v6, s[12:15], s88 offen offset:128
    s_add_u32 s87, s87, 0x20000
    s_add_u32 s88, s88, 0x10000
    s_add_u32 s89, s89, 512
    s_barrier
    s_barrier
    s_waitcnt vmcnt(0)
    v_lshlrev_b32 v88, 16, v48
    v_lshlrev_b32 v89, 16, v49
    v_mul_f32 v88, 0x3e0293ee, v88
    v_cvt_f32_i32 v16, v16
    v_cvt_f32_i32 v17, v17
    v_cvt_f32_i32 v18, v18
    v_cvt_f32_i32 v19, v19
    v_cvt_f32_i32 v20, v20
    v_cvt_f32_i32 v21, v21
    v_cvt_f32_i32 v22, v22
    v_cvt_f32_i32 v23, v23
    v_cvt_f32_i32 v24, v24
    v_cvt_f32_i32 v25, v25
    v_cvt_f32_i32 v26, v26
    v_cvt_f32_i32 v27, v27
    v_cvt_f32_i32 v28, v28
    v_cvt_f32_i32 v29, v29
    v_cvt_f32_i32 v30, v30
    v_cvt_f32_i32 v31, v31
    v_mul_f32 v89, v89, v88
    v_fma_f32 v16, v16, v88, -v89
    v_fma_f32 v17, v17, v88, -v89
    v_fma_f32 v18, v18, v88, -v89
    v_fma_f32 v19, v19, v88, -v89
    v_fma_f32 v20, v20, v88, -v89
    v_fma_f32 v21, v21, v88, -v89
    v_fma_f32 v22, v22, v88, -v89
    v_fma_f32 v23, v23, v88, -v89
    v_fma_f32 v24, v24, v88, -v89
    v_fma_f32 v25, v25, v88, -v89
    v_fma_f32 v26, v26, v88, -v89
    v_fma_f32 v27, v27, v88, -v89
    v_fma_f32 v28, v28, v88, -v89
    v_fma_f32 v29, v29, v88, -v89
    v_fma_f32 v30, v30, v88, -v89
    v_fma_f32 v31, v31, v88, -v89
    v_lshlrev_b32 v90, 16, v32
    v_lshlrev_b32 v91, 16, v36
    v_lshlrev_b32 v92, 16, v40
    v_lshlrev_b32 v93, 16, v44
    v_mul_f32 v92, v24, v92
    v_mul_f32 v93, v16, v93
    v_fma_f32 v94, v16, v90, -v92
    v_fma_f32 v96, v24, v91, v93
    v_and_b32 v90, 0xffff0000, v32
    v_and_b32 v91, 0xffff0000, v36
    v_and_b32 v92, 0xffff0000, v40
    v_and_b32 v93, 0xffff0000, v44
    v_mul_f32 v92, v25, v92
    v_mul_f32 v93, v17, v93
    v_fma_f32 v95, v17, v90, -v92
    v_fma_f32 v97, v25, v91, v93
    v_cvt_pk_bf16_f32 v104, v94, v95
    v_cvt_pk_bf16_f32 v106, v96, v97
    v_lshlrev_b32 v90, 16, v33
    v_lshlrev_b32 v91, 16, v37
    v_lshlrev_b32 v92, 16, v41
    v_lshlrev_b32 v93, 16, v45
    v_mul_f32 v92, v26, v92
    buffer_load_ushort v84, v7, s[32:35], s89 offen
    buffer_load_ushort v85, v7, s[36:39], s89 offen
    buffer_load_dwordx4 v[52:55], v5, s[4:7], s87 offen offset:0 nt
    buffer_load_dwordx4 v[56:59], v5, s[4:7], s87 offen offset:16 nt
    buffer_load_dwordx4 v[60:63], v5, s[4:7], s87 offen offset:256 nt
    buffer_load_dwordx4 v[64:67], v5, s[4:7], s87 offen offset:272 nt
    buffer_load_dwordx4 v[68:71], v6, s[8:11], s88 offen offset:0
    buffer_load_dwordx4 v[72:75], v6, s[8:11], s88 offen offset:128
    buffer_load_dwordx4 v[76:79], v6, s[12:15], s88 offen offset:0
    buffer_load_dwordx4 v[80:83], v6, s[12:15], s88 offen offset:128
    s_add_u32 s87, s87, 0x20000
    s_add_u32 s88, s88, 0x10000
    s_add_u32 s89, s89, 512
    s_barrier
    v_mul_f32 v93, v18, v93
    v_fma_f32 v94, v18, v90, -v92
    v_fma_f32 v96, v26, v91, v93
    v_and_b32 v90, 0xffff0000, v33
    v_and_b32 v91, 0xffff0000, v37
    v_and_b32 v92, 0xffff0000, v41
    v_and_b32 v93, 0xffff0000, v45
    v_mul_f32 v92, v27, v92
    v_mul_f32 v93, v19, v93
    v_fma_f32 v95, v19, v90, -v92
    v_fma_f32 v97, v27, v91, v93
    v_cvt_pk_bf16_f32 v105, v94, v95
    v_cvt_pk_bf16_f32 v107, v96, v97
    v_lshlrev_b32 v90, 16, v34
    v_lshlrev_b32 v91, 16, v38
    v_lshlrev_b32 v92, 16, v42
    v_lshlrev_b32 v93, 16, v46
    v_mul_f32 v92, v28, v92
    v_mul_f32 v93, v20, v93
    v_fma_f32 v94, v20, v90, -v92
    v_fma_f32 v96, v28, v91, v93
    v_and_b32 v90, 0xffff0000, v34
    v_and_b32 v91, 0xffff0000, v38
    v_and_b32 v92, 0xffff0000, v42
    v_and_b32 v93, 0xffff0000, v46
    v_mul_f32 v92, v29, v92
    v_mul_f32 v93, v21, v93
    v_fma_f32 v95, v21, v90, -v92
    v_fma_f32 v97, v29, v91, v93
    v_cvt_pk_bf16_f32 v108, v94, v95
    v_cvt_pk_bf16_f32 v110, v96, v97
    v_lshlrev_b32 v90, 16, v35
    v_lshlrev_b32 v91, 16, v39
    v_lshlrev_b32 v92, 16, v43
    v_lshlrev_b32 v93, 16, v47
    v_mul_f32 v92, v30, v92
    v_mul_f32 v93, v22, v93
    v_fma_f32 v94, v22, v90, -v92
    v_fma_f32 v96, v30, v91, v93
    v_and_b32 v90, 0xffff0000, v35
    v_and_b32 v91, 0xffff0000, v39
    v_and_b32 v92, 0xffff0000, v43
    v_and_b32 v93, 0xffff0000, v47
    v_mul_f32 v92, v31, v92
    v_mul_f32 v93, v23, v93
    v_fma_f32 v95, v23, v90, -v92
    v_fma_f32 v97, v31, v91, v93
    v_cvt_pk_bf16_f32 v109, v94, v95
    v_cvt_pk_bf16_f32 v111, v96, v97
    ds_bpermute_b32 v104, v14, v104
    ds_bpermute_b32 v105, v14, v105
    ds_bpermute_b32 v106, v14, v106
    ds_bpermute_b32 v107, v14, v107
    ds_bpermute_b32 v108, v14, v108
    ds_bpermute_b32 v109, v14, v109
    ds_bpermute_b32 v110, v14, v110
    ds_bpermute_b32 v111, v14, v111
    s_waitcnt lgkmcnt(0)
    buffer_store_dwordx4 v[104:107], v8, s[24:27], s90 offen offset:0 sc0 sc1
    buffer_store_dwordx4 v[108:111], v8, s[24:27], s90 offen offset:1024 sc0 sc1
    s_add_u32 s90, s90, 0x20000
    s_barrier
    s_barrier
    s_waitcnt vmcnt(0)
    s_add_u32 s85, s40, 3
    v_mov_b32 v10, s85
    v_mov_b32 v11, s84
    s_mov_b64 exec, 1
    buffer_store_dword v10, v11, s[72:75], 0 offen sc0 sc1
    s_mov_b64 exec, -1
    v_lshlrev_b32 v88, 16, v84
    v_lshlrev_b32 v89, 16, v85
    v_mul_f32 v88, 0x3e0293ee, v88
    v_cvt_f32_i32 v52, v52
    v_cvt_f32_i32 v53, v53
    v_cvt_f32_i32 v54, v54
    v_cvt_f32_i32 v55, v55
    v_cvt_f32_i32 v56, v56
    v_cvt_f32_i32 v57, v57
    v_cvt_f32_i32 v58, v58
    v_cvt_f32_i32 v59, v59
    v_cvt_f32_i32 v60, v60
    v_cvt_f32_i32 v61, v61
    v_cvt_f32_i32 v62, v62
    v_cvt_f32_i32 v63, v63
    v_cvt_f32_i32 v64, v64
    v_cvt_f32_i32 v65, v65
    v_cvt_f32_i32 v66, v66
    v_cvt_f32_i32 v67, v67
    v_mul_f32 v89, v89, v88
    v_fma_f32 v52, v52, v88, -v89
    v_fma_f32 v53, v53, v88, -v89
    v_fma_f32 v54, v54, v88, -v89
    v_fma_f32 v55, v55, v88, -v89
    v_fma_f32 v56, v56, v88, -v89
    v_fma_f32 v57, v57, v88, -v89
    v_fma_f32 v58, v58, v88, -v89
    v_fma_f32 v59, v59, v88, -v89
    v_fma_f32 v60, v60, v88, -v89
    v_fma_f32 v61, v61, v88, -v89
    v_fma_f32 v62, v62, v88, -v89
    v_fma_f32 v63, v63, v88, -v89
    v_fma_f32 v64, v64, v88, -v89
    v_fma_f32 v65, v65, v88, -v89
    v_fma_f32 v66, v66, v88, -v89
    v_fma_f32 v67, v67, v88, -v89
    v_lshlrev_b32 v90, 16, v68
    v_lshlrev_b32 v91, 16, v72
    v_lshlrev_b32 v92, 16, v76
    v_lshlrev_b32 v93, 16, v80
    v_mul_f32 v92, v60, v92
    v_mul_f32 v93, v52, v93
    v_fma_f32 v94, v52, v90, -v92
    v_fma_f32 v96, v60, v91, v93
    v_and_b32 v90, 0xffff0000, v68
    v_and_b32 v91, 0xffff0000, v72
    v_and_b32 v92, 0xffff0000, v76
    v_and_b32 v93, 0xffff0000, v80
    v_mul_f32 v92, v61, v92
    v_mul_f32 v93, v53, v93
    v_fma_f32 v95, v53, v90, -v92
    v_fma_f32 v97, v61, v91, v93
    v_cvt_pk_bf16_f32 v112, v94, v95
    v_cvt_pk_bf16_f32 v114, v96, v97
    v_lshlrev_b32 v90, 16, v69
    v_lshlrev_b32 v91, 16, v73
    v_lshlrev_b32 v92, 16, v77
    v_lshlrev_b32 v93, 16, v81
    v_mul_f32 v92, v62, v92
    buffer_load_ushort v48, v7, s[32:35], s89 offen
    buffer_load_ushort v49, v7, s[36:39], s89 offen
    buffer_load_dwordx4 v[16:19], v5, s[4:7], s87 offen offset:0 nt
    buffer_load_dwordx4 v[20:23], v5, s[4:7], s87 offen offset:16 nt
    buffer_load_dwordx4 v[24:27], v5, s[4:7], s87 offen offset:256 nt
    buffer_load_dwordx4 v[28:31], v5, s[4:7], s87 offen offset:272 nt
    buffer_load_dwordx4 v[32:35], v6, s[8:11], s88 offen offset:0
    buffer_load_dwordx4 v[36:39], v6, s[8:11], s88 offen offset:128
    buffer_load_dwordx4 v[40:43], v6, s[12:15], s88 offen offset:0
    buffer_load_dwordx4 v[44:47], v6, s[12:15], s88 offen offset:128
    s_add_u32 s87, s87, 0x20000
    s_add_u32 s88, s88, 0x10000
    s_add_u32 s89, s89, 512
    s_barrier
    v_mul_f32 v93, v54, v93
    v_fma_f32 v94, v54, v90, -v92
    v_fma_f32 v96, v62, v91, v93
    v_and_b32 v90, 0xffff0000, v69
    v_and_b32 v91, 0xffff0000, v73
    v_and_b32 v92, 0xffff0000, v77
    v_and_b32 v93, 0xffff0000, v81
    v_mul_f32 v92, v63, v92
    v_mul_f32 v93, v55, v93
    v_fma_f32 v95, v55, v90, -v92
    v_fma_f32 v97, v63, v91, v93
    v_cvt_pk_bf16_f32 v113, v94, v95
    v_cvt_pk_bf16_f32 v115, v96, v97
    v_lshlrev_b32 v90, 16, v70
    v_lshlrev_b32 v91, 16, v74
    v_lshlrev_b32 v92, 16, v78
    v_lshlrev_b32 v93, 16, v82
    v_mul_f32 v92, v64, v92
    v_mul_f32 v93, v56, v93
    v_fma_f32 v94, v56, v90, -v92
    v_fma_f32 v96, v64, v91, v93
    v_and_b32 v90, 0xffff0000, v70
    v_and_b32 v91, 0xffff0000, v74
    v_and_b32 v92, 0xffff0000, v78
    v_and_b32 v93, 0xffff0000, v82
    v_mul_f32 v92, v65, v92
    v_mul_f32 v93, v57, v93
    v_fma_f32 v95, v57, v90, -v92
    v_fma_f32 v97, v65, v91, v93
    v_cvt_pk_bf16_f32 v116, v94, v95
    v_cvt_pk_bf16_f32 v118, v96, v97
    v_lshlrev_b32 v90, 16, v71
    v_lshlrev_b32 v91, 16, v75
    v_lshlrev_b32 v92, 16, v79
    v_lshlrev_b32 v93, 16, v83
    v_mul_f32 v92, v66, v92
    v_mul_f32 v93, v58, v93
    v_fma_f32 v94, v58, v90, -v92
    v_fma_f32 v96, v66, v91, v93
    v_and_b32 v90, 0xffff0000, v71
    v_and_b32 v91, 0xffff0000, v75
    v_and_b32 v92, 0xffff0000, v79
    v_and_b32 v93, 0xffff0000, v83
    v_mul_f32 v92, v67, v92
    v_mul_f32 v93, v59, v93
    v_fma_f32 v95, v59, v90, -v92
    v_fma_f32 v97, v67, v91, v93
    v_cvt_pk_bf16_f32 v117, v94, v95
    v_cvt_pk_bf16_f32 v119, v96, v97
    ds_bpermute_b32 v112, v14, v112
    ds_bpermute_b32 v113, v14, v113
    ds_bpermute_b32 v114, v14, v114
    ds_bpermute_b32 v115, v14, v115
    ds_bpermute_b32 v116, v14, v116
    ds_bpermute_b32 v117, v14, v117
    ds_bpermute_b32 v118, v14, v118
    ds_bpermute_b32 v119, v14, v119
    s_waitcnt lgkmcnt(0)
    buffer_store_dwordx4 v[112:115], v8, s[24:27], s90 offen offset:0 sc0 sc1
    buffer_store_dwordx4 v[116:119], v8, s[24:27], s90 offen offset:1024 sc0 sc1
    s_add_u32 s90, s90, 0x20000
    s_barrier
    s_barrier
    s_waitcnt vmcnt(0)
    s_add_u32 s85, s40, 4
    v_mov_b32 v10, s85
    v_mov_b32 v11, s84
    s_mov_b64 exec, 1
    buffer_store_dword v10, v11, s[72:75], 0 offen sc0 sc1
    s_mov_b64 exec, -1
    v_lshlrev_b32 v88, 16, v48
    v_lshlrev_b32 v89, 16, v49
    v_mul_f32 v88, 0x3e0293ee, v88
    v_cvt_f32_i32 v16, v16
    v_cvt_f32_i32 v17, v17
    v_cvt_f32_i32 v18, v18
    v_cvt_f32_i32 v19, v19
    v_cvt_f32_i32 v20, v20
    v_cvt_f32_i32 v21, v21
    v_cvt_f32_i32 v22, v22
    v_cvt_f32_i32 v23, v23
    v_cvt_f32_i32 v24, v24
    v_cvt_f32_i32 v25, v25
    v_cvt_f32_i32 v26, v26
    v_cvt_f32_i32 v27, v27
    v_cvt_f32_i32 v28, v28
    v_cvt_f32_i32 v29, v29
    v_cvt_f32_i32 v30, v30
    v_cvt_f32_i32 v31, v31
    v_mul_f32 v89, v89, v88
    v_fma_f32 v16, v16, v88, -v89
    v_fma_f32 v17, v17, v88, -v89
    v_fma_f32 v18, v18, v88, -v89
    v_fma_f32 v19, v19, v88, -v89
    v_fma_f32 v20, v20, v88, -v89
    v_fma_f32 v21, v21, v88, -v89
    v_fma_f32 v22, v22, v88, -v89
    v_fma_f32 v23, v23, v88, -v89
    v_fma_f32 v24, v24, v88, -v89
    v_fma_f32 v25, v25, v88, -v89
    v_fma_f32 v26, v26, v88, -v89
    v_fma_f32 v27, v27, v88, -v89
    v_fma_f32 v28, v28, v88, -v89
    v_fma_f32 v29, v29, v88, -v89
    v_fma_f32 v30, v30, v88, -v89
    v_fma_f32 v31, v31, v88, -v89
    v_lshlrev_b32 v90, 16, v32
    v_lshlrev_b32 v91, 16, v36
    v_lshlrev_b32 v92, 16, v40
    v_lshlrev_b32 v93, 16, v44
    v_mul_f32 v92, v24, v92
    v_mul_f32 v93, v16, v93
    v_fma_f32 v94, v16, v90, -v92
    v_fma_f32 v96, v24, v91, v93
    v_and_b32 v90, 0xffff0000, v32
    v_and_b32 v91, 0xffff0000, v36
    v_and_b32 v92, 0xffff0000, v40
    v_and_b32 v93, 0xffff0000, v44
    v_mul_f32 v92, v25, v92
    v_mul_f32 v93, v17, v93
    v_fma_f32 v95, v17, v90, -v92
    v_fma_f32 v97, v25, v91, v93
    v_cvt_pk_bf16_f32 v104, v94, v95
    v_cvt_pk_bf16_f32 v106, v96, v97
    v_lshlrev_b32 v90, 16, v33
    v_lshlrev_b32 v91, 16, v37
    v_lshlrev_b32 v92, 16, v41
    v_lshlrev_b32 v93, 16, v45
    v_mul_f32 v92, v26, v92
    buffer_load_ushort v84, v7, s[32:35], s89 offen
    buffer_load_ushort v85, v7, s[36:39], s89 offen
    buffer_load_dwordx4 v[52:55], v5, s[4:7], s87 offen offset:0 nt
    buffer_load_dwordx4 v[56:59], v5, s[4:7], s87 offen offset:16 nt
    buffer_load_dwordx4 v[60:63], v5, s[4:7], s87 offen offset:256 nt
    buffer_load_dwordx4 v[64:67], v5, s[4:7], s87 offen offset:272 nt
    buffer_load_dwordx4 v[68:71], v6, s[8:11], s88 offen offset:0
    buffer_load_dwordx4 v[72:75], v6, s[8:11], s88 offen offset:128
    buffer_load_dwordx4 v[76:79], v6, s[12:15], s88 offen offset:0
    buffer_load_dwordx4 v[80:83], v6, s[12:15], s88 offen offset:128
    s_add_u32 s87, s87, 0x20000
    s_add_u32 s88, s88, 0x10000
    s_add_u32 s89, s89, 512
    s_barrier
    v_mul_f32 v93, v18, v93
    v_fma_f32 v94, v18, v90, -v92
    v_fma_f32 v96, v26, v91, v93
    v_and_b32 v90, 0xffff0000, v33
    v_and_b32 v91, 0xffff0000, v37
    v_and_b32 v92, 0xffff0000, v41
    v_and_b32 v93, 0xffff0000, v45
    v_mul_f32 v92, v27, v92
    v_mul_f32 v93, v19, v93
    v_fma_f32 v95, v19, v90, -v92
    v_fma_f32 v97, v27, v91, v93
    v_cvt_pk_bf16_f32 v105, v94, v95
    v_cvt_pk_bf16_f32 v107, v96, v97
    v_lshlrev_b32 v90, 16, v34
    v_lshlrev_b32 v91, 16, v38
    v_lshlrev_b32 v92, 16, v42
    v_lshlrev_b32 v93, 16, v46
    v_mul_f32 v92, v28, v92
    v_mul_f32 v93, v20, v93
    v_fma_f32 v94, v20, v90, -v92
    v_fma_f32 v96, v28, v91, v93
    v_and_b32 v90, 0xffff0000, v34
    v_and_b32 v91, 0xffff0000, v38
    v_and_b32 v92, 0xffff0000, v42
    v_and_b32 v93, 0xffff0000, v46
    v_mul_f32 v92, v29, v92
    v_mul_f32 v93, v21, v93
    v_fma_f32 v95, v21, v90, -v92
    v_fma_f32 v97, v29, v91, v93
    v_cvt_pk_bf16_f32 v108, v94, v95
    v_cvt_pk_bf16_f32 v110, v96, v97
    v_lshlrev_b32 v90, 16, v35
    v_lshlrev_b32 v91, 16, v39
    v_lshlrev_b32 v92, 16, v43
    v_lshlrev_b32 v93, 16, v47
    v_mul_f32 v92, v30, v92
    v_mul_f32 v93, v22, v93
    v_fma_f32 v94, v22, v90, -v92
    v_fma_f32 v96, v30, v91, v93
    v_and_b32 v90, 0xffff0000, v35
    v_and_b32 v91, 0xffff0000, v39
    v_and_b32 v92, 0xffff0000, v43
    v_and_b32 v93, 0xffff0000, v47
    v_mul_f32 v92, v31, v92
    v_mul_f32 v93, v23, v93
    v_fma_f32 v95, v23, v90, -v92
    v_fma_f32 v97, v31, v91, v93
    v_cvt_pk_bf16_f32 v109, v94, v95
    v_cvt_pk_bf16_f32 v111, v96, v97
    ds_bpermute_b32 v104, v14, v104
    ds_bpermute_b32 v105, v14, v105
    ds_bpermute_b32 v106, v14, v106
    ds_bpermute_b32 v107, v14, v107
    ds_bpermute_b32 v108, v14, v108
    ds_bpermute_b32 v109, v14, v109
    ds_bpermute_b32 v110, v14, v110
    ds_bpermute_b32 v111, v14, v111
    s_waitcnt lgkmcnt(0)
    buffer_store_dwordx4 v[104:107], v8, s[24:27], s90 offen offset:0 sc0 sc1
    buffer_store_dwordx4 v[108:111], v8, s[24:27], s90 offen offset:1024 sc0 sc1
    s_add_u32 s90, s90, 0x20000
    s_barrier
    s_barrier
    s_barrier
    s_waitcnt vmcnt(0)
    s_add_u32 s85, s40, 5
    v_mov_b32 v10, s85
    v_mov_b32 v11, s84
    s_mov_b64 exec, 1
    buffer_store_dword v10, v11, s[72:75], 0 offen sc0 sc1
    s_mov_b64 exec, -1
    v_lshlrev_b32 v88, 16, v84
    v_lshlrev_b32 v89, 16, v85
    v_mul_f32 v88, 0x3e0293ee, v88
    v_cvt_f32_i32 v52, v52
    v_cvt_f32_i32 v53, v53
    v_cvt_f32_i32 v54, v54
    v_cvt_f32_i32 v55, v55
    v_cvt_f32_i32 v56, v56
    v_cvt_f32_i32 v57, v57
    v_cvt_f32_i32 v58, v58
    v_cvt_f32_i32 v59, v59
    v_cvt_f32_i32 v60, v60
    v_cvt_f32_i32 v61, v61
    v_cvt_f32_i32 v62, v62
    v_cvt_f32_i32 v63, v63
    v_cvt_f32_i32 v64, v64
    v_cvt_f32_i32 v65, v65
    v_cvt_f32_i32 v66, v66
    v_cvt_f32_i32 v67, v67
    v_mul_f32 v89, v89, v88
    v_fma_f32 v52, v52, v88, -v89
    v_fma_f32 v53, v53, v88, -v89
    v_fma_f32 v54, v54, v88, -v89
    v_fma_f32 v55, v55, v88, -v89
    v_fma_f32 v56, v56, v88, -v89
    v_fma_f32 v57, v57, v88, -v89
    v_fma_f32 v58, v58, v88, -v89
    v_fma_f32 v59, v59, v88, -v89
    v_fma_f32 v60, v60, v88, -v89
    v_fma_f32 v61, v61, v88, -v89
    v_fma_f32 v62, v62, v88, -v89
    v_fma_f32 v63, v63, v88, -v89
    v_fma_f32 v64, v64, v88, -v89
    v_fma_f32 v65, v65, v88, -v89
    v_fma_f32 v66, v66, v88, -v89
    v_fma_f32 v67, v67, v88, -v89
    v_lshlrev_b32 v90, 16, v68
    v_lshlrev_b32 v91, 16, v72
    v_lshlrev_b32 v92, 16, v76
    v_lshlrev_b32 v93, 16, v80
    v_mul_f32 v92, v60, v92
    v_mul_f32 v93, v52, v93
    v_fma_f32 v94, v52, v90, -v92
    v_fma_f32 v96, v60, v91, v93
    v_and_b32 v90, 0xffff0000, v68
    v_and_b32 v91, 0xffff0000, v72
    v_and_b32 v92, 0xffff0000, v76
    v_and_b32 v93, 0xffff0000, v80
    v_mul_f32 v92, v61, v92
    v_mul_f32 v93, v53, v93
    v_fma_f32 v95, v53, v90, -v92
    v_fma_f32 v97, v61, v91, v93
    v_cvt_pk_bf16_f32 v112, v94, v95
    v_cvt_pk_bf16_f32 v114, v96, v97
    v_lshlrev_b32 v90, 16, v69
    v_lshlrev_b32 v91, 16, v73
    v_lshlrev_b32 v92, 16, v77
    v_lshlrev_b32 v93, 16, v81
    v_mul_f32 v92, v62, v92
    buffer_load_ushort v48, v7, s[32:35], s89 offen
    buffer_load_ushort v49, v7, s[36:39], s89 offen
    buffer_load_dwordx4 v[16:19], v5, s[4:7], s87 offen offset:0 nt
    buffer_load_dwordx4 v[20:23], v5, s[4:7], s87 offen offset:16 nt
    buffer_load_dwordx4 v[24:27], v5, s[4:7], s87 offen offset:256 nt
    buffer_load_dwordx4 v[28:31], v5, s[4:7], s87 offen offset:272 nt
    buffer_load_dwordx4 v[32:35], v6, s[8:11], s88 offen offset:0
    buffer_load_dwordx4 v[36:39], v6, s[8:11], s88 offen offset:128
    buffer_load_dwordx4 v[40:43], v6, s[12:15], s88 offen offset:0
    buffer_load_dwordx4 v[44:47], v6, s[12:15], s88 offen offset:128
    s_add_u32 s87, s87, 0x20000
    s_add_u32 s88, s88, 0x10000
    s_add_u32 s89, s89, 512
    s_barrier
    v_mul_f32 v93, v54, v93
    v_fma_f32 v94, v54, v90, -v92
    v_fma_f32 v96, v62, v91, v93
    v_and_b32 v90, 0xffff0000, v69
    v_and_b32 v91, 0xffff0000, v73
    v_and_b32 v92, 0xffff0000, v77
    v_and_b32 v93, 0xffff0000, v81
    v_mul_f32 v92, v63, v92
    v_mul_f32 v93, v55, v93
    v_fma_f32 v95, v55, v90, -v92
    v_fma_f32 v97, v63, v91, v93
    v_cvt_pk_bf16_f32 v113, v94, v95
    v_cvt_pk_bf16_f32 v115, v96, v97
    v_lshlrev_b32 v90, 16, v70
    v_lshlrev_b32 v91, 16, v74
    v_lshlrev_b32 v92, 16, v78
    v_lshlrev_b32 v93, 16, v82
    v_mul_f32 v92, v64, v92
    v_mul_f32 v93, v56, v93
    v_fma_f32 v94, v56, v90, -v92
    v_fma_f32 v96, v64, v91, v93
    v_and_b32 v90, 0xffff0000, v70
    v_and_b32 v91, 0xffff0000, v74
    v_and_b32 v92, 0xffff0000, v78
    v_and_b32 v93, 0xffff0000, v82
    v_mul_f32 v92, v65, v92
    v_mul_f32 v93, v57, v93
    v_fma_f32 v95, v57, v90, -v92
    v_fma_f32 v97, v65, v91, v93
    v_cvt_pk_bf16_f32 v116, v94, v95
    v_cvt_pk_bf16_f32 v118, v96, v97
    v_lshlrev_b32 v90, 16, v71
    v_lshlrev_b32 v91, 16, v75
    v_lshlrev_b32 v92, 16, v79
    v_lshlrev_b32 v93, 16, v83
    v_mul_f32 v92, v66, v92
    v_mul_f32 v93, v58, v93
    v_fma_f32 v94, v58, v90, -v92
    v_fma_f32 v96, v66, v91, v93
    v_and_b32 v90, 0xffff0000, v71
    v_and_b32 v91, 0xffff0000, v75
    v_and_b32 v92, 0xffff0000, v79
    v_and_b32 v93, 0xffff0000, v83
    v_mul_f32 v92, v67, v92
    v_mul_f32 v93, v59, v93
    v_fma_f32 v95, v59, v90, -v92
    v_fma_f32 v97, v67, v91, v93
    v_cvt_pk_bf16_f32 v117, v94, v95
    v_cvt_pk_bf16_f32 v119, v96, v97
    ds_bpermute_b32 v112, v14, v112
    ds_bpermute_b32 v113, v14, v113
    ds_bpermute_b32 v114, v14, v114
    ds_bpermute_b32 v115, v14, v115
    ds_bpermute_b32 v116, v14, v116
    ds_bpermute_b32 v117, v14, v117
    ds_bpermute_b32 v118, v14, v118
    ds_bpermute_b32 v119, v14, v119
    s_waitcnt lgkmcnt(0)
    buffer_store_dwordx4 v[112:115], v8, s[24:27], s90 offen offset:0 sc0 sc1
    buffer_store_dwordx4 v[116:119], v8, s[24:27], s90 offen offset:1024 sc0 sc1
    s_add_u32 s90, s90, 0x20000
    s_barrier
    s_barrier
    s_barrier
    s_waitcnt vmcnt(0)
    s_add_u32 s85, s40, 6
    v_mov_b32 v10, s85
    v_mov_b32 v11, s84
    s_mov_b64 exec, 1
    buffer_store_dword v10, v11, s[72:75], 0 offen sc0 sc1
    s_mov_b64 exec, -1
    v_lshlrev_b32 v88, 16, v48
    v_lshlrev_b32 v89, 16, v49
    v_mul_f32 v88, 0x3e0293ee, v88
    v_cvt_f32_i32 v16, v16
    v_cvt_f32_i32 v17, v17
    v_cvt_f32_i32 v18, v18
    v_cvt_f32_i32 v19, v19
    v_cvt_f32_i32 v20, v20
    v_cvt_f32_i32 v21, v21
    v_cvt_f32_i32 v22, v22
    v_cvt_f32_i32 v23, v23
    v_cvt_f32_i32 v24, v24
    v_cvt_f32_i32 v25, v25
    v_cvt_f32_i32 v26, v26
    v_cvt_f32_i32 v27, v27
    v_cvt_f32_i32 v28, v28
    v_cvt_f32_i32 v29, v29
    v_cvt_f32_i32 v30, v30
    v_cvt_f32_i32 v31, v31
    v_mul_f32 v89, v89, v88
    v_fma_f32 v16, v16, v88, -v89
    v_fma_f32 v17, v17, v88, -v89
    v_fma_f32 v18, v18, v88, -v89
    v_fma_f32 v19, v19, v88, -v89
    v_fma_f32 v20, v20, v88, -v89
    v_fma_f32 v21, v21, v88, -v89
    v_fma_f32 v22, v22, v88, -v89
    v_fma_f32 v23, v23, v88, -v89
    v_fma_f32 v24, v24, v88, -v89
    v_fma_f32 v25, v25, v88, -v89
    v_fma_f32 v26, v26, v88, -v89
    v_fma_f32 v27, v27, v88, -v89
    v_fma_f32 v28, v28, v88, -v89
    v_fma_f32 v29, v29, v88, -v89
    v_fma_f32 v30, v30, v88, -v89
    v_fma_f32 v31, v31, v88, -v89
    v_lshlrev_b32 v90, 16, v32
    v_lshlrev_b32 v91, 16, v36
    v_lshlrev_b32 v92, 16, v40
    v_lshlrev_b32 v93, 16, v44
    v_mul_f32 v92, v24, v92
    v_mul_f32 v93, v16, v93
    v_fma_f32 v94, v16, v90, -v92
    v_fma_f32 v96, v24, v91, v93
    v_and_b32 v90, 0xffff0000, v32
    v_and_b32 v91, 0xffff0000, v36
    v_and_b32 v92, 0xffff0000, v40
    v_and_b32 v93, 0xffff0000, v44
    v_mul_f32 v92, v25, v92
    v_mul_f32 v93, v17, v93
    v_fma_f32 v95, v17, v90, -v92
    v_fma_f32 v97, v25, v91, v93
    v_cvt_pk_bf16_f32 v104, v94, v95
    v_cvt_pk_bf16_f32 v106, v96, v97
    v_lshlrev_b32 v90, 16, v33
    v_lshlrev_b32 v91, 16, v37
    v_lshlrev_b32 v92, 16, v41
    v_lshlrev_b32 v93, 16, v45
    v_mul_f32 v92, v26, v92
    buffer_load_ushort v84, v7, s[32:35], s89 offen
    buffer_load_ushort v85, v7, s[36:39], s89 offen
    buffer_load_dwordx4 v[52:55], v5, s[4:7], s87 offen offset:0 nt
    buffer_load_dwordx4 v[56:59], v5, s[4:7], s87 offen offset:16 nt
    buffer_load_dwordx4 v[60:63], v5, s[4:7], s87 offen offset:256 nt
    buffer_load_dwordx4 v[64:67], v5, s[4:7], s87 offen offset:272 nt
    buffer_load_dwordx4 v[68:71], v6, s[8:11], s88 offen offset:0
    buffer_load_dwordx4 v[72:75], v6, s[8:11], s88 offen offset:128
    buffer_load_dwordx4 v[76:79], v6, s[12:15], s88 offen offset:0
    buffer_load_dwordx4 v[80:83], v6, s[12:15], s88 offen offset:128
    s_add_u32 s87, s87, 0x20000
    s_add_u32 s88, s88, 0x10000
    s_add_u32 s89, s89, 512
    s_barrier
    v_mul_f32 v93, v18, v93
    v_fma_f32 v94, v18, v90, -v92
    v_fma_f32 v96, v26, v91, v93
    v_and_b32 v90, 0xffff0000, v33
    v_and_b32 v91, 0xffff0000, v37
    v_and_b32 v92, 0xffff0000, v41
    v_and_b32 v93, 0xffff0000, v45
    v_mul_f32 v92, v27, v92
    v_mul_f32 v93, v19, v93
    v_fma_f32 v95, v19, v90, -v92
    v_fma_f32 v97, v27, v91, v93
    v_cvt_pk_bf16_f32 v105, v94, v95
    v_cvt_pk_bf16_f32 v107, v96, v97
    v_lshlrev_b32 v90, 16, v34
    v_lshlrev_b32 v91, 16, v38
    v_lshlrev_b32 v92, 16, v42
    v_lshlrev_b32 v93, 16, v46
    v_mul_f32 v92, v28, v92
    v_mul_f32 v93, v20, v93
    v_fma_f32 v94, v20, v90, -v92
    v_fma_f32 v96, v28, v91, v93
    v_and_b32 v90, 0xffff0000, v34
    v_and_b32 v91, 0xffff0000, v38
    v_and_b32 v92, 0xffff0000, v42
    v_and_b32 v93, 0xffff0000, v46
    v_mul_f32 v92, v29, v92
    v_mul_f32 v93, v21, v93
    v_fma_f32 v95, v21, v90, -v92
    v_fma_f32 v97, v29, v91, v93
    v_cvt_pk_bf16_f32 v108, v94, v95
    v_cvt_pk_bf16_f32 v110, v96, v97
    v_lshlrev_b32 v90, 16, v35
    v_lshlrev_b32 v91, 16, v39
    v_lshlrev_b32 v92, 16, v43
    v_lshlrev_b32 v93, 16, v47
    v_mul_f32 v92, v30, v92
    v_mul_f32 v93, v22, v93
    v_fma_f32 v94, v22, v90, -v92
    v_fma_f32 v96, v30, v91, v93
    v_and_b32 v90, 0xffff0000, v35
    v_and_b32 v91, 0xffff0000, v39
    v_and_b32 v92, 0xffff0000, v43
    v_and_b32 v93, 0xffff0000, v47
    v_mul_f32 v92, v31, v92
    v_mul_f32 v93, v23, v93
    v_fma_f32 v95, v23, v90, -v92
    v_fma_f32 v97, v31, v91, v93
    v_cvt_pk_bf16_f32 v109, v94, v95
    v_cvt_pk_bf16_f32 v111, v96, v97
    ds_bpermute_b32 v104, v14, v104
    ds_bpermute_b32 v105, v14, v105
    ds_bpermute_b32 v106, v14, v106
    ds_bpermute_b32 v107, v14, v107
    ds_bpermute_b32 v108, v14, v108
    ds_bpermute_b32 v109, v14, v109
    ds_bpermute_b32 v110, v14, v110
    ds_bpermute_b32 v111, v14, v111
    s_waitcnt lgkmcnt(0)
    buffer_store_dwordx4 v[104:107], v8, s[24:27], s90 offen offset:0 sc0 sc1
    buffer_store_dwordx4 v[108:111], v8, s[24:27], s90 offen offset:1024 sc0 sc1
    s_add_u32 s90, s90, 0x20000
    s_barrier
    s_barrier
    s_barrier
    s_waitcnt vmcnt(0)
    s_add_u32 s85, s40, 7
    v_mov_b32 v10, s85
    v_mov_b32 v11, s84
    s_mov_b64 exec, 1
    buffer_store_dword v10, v11, s[72:75], 0 offen sc0 sc1
    s_mov_b64 exec, -1
    v_lshlrev_b32 v88, 16, v84
    v_lshlrev_b32 v89, 16, v85
    v_mul_f32 v88, 0x3e0293ee, v88
    v_cvt_f32_i32 v52, v52
    v_cvt_f32_i32 v53, v53
    v_cvt_f32_i32 v54, v54
    v_cvt_f32_i32 v55, v55
    v_cvt_f32_i32 v56, v56
    v_cvt_f32_i32 v57, v57
    v_cvt_f32_i32 v58, v58
    v_cvt_f32_i32 v59, v59
    v_cvt_f32_i32 v60, v60
    v_cvt_f32_i32 v61, v61
    v_cvt_f32_i32 v62, v62
    v_cvt_f32_i32 v63, v63
    v_cvt_f32_i32 v64, v64
    v_cvt_f32_i32 v65, v65
    v_cvt_f32_i32 v66, v66
    v_cvt_f32_i32 v67, v67
    v_mul_f32 v89, v89, v88
    v_fma_f32 v52, v52, v88, -v89
    v_fma_f32 v53, v53, v88, -v89
    v_fma_f32 v54, v54, v88, -v89
    v_fma_f32 v55, v55, v88, -v89
    v_fma_f32 v56, v56, v88, -v89
    v_fma_f32 v57, v57, v88, -v89
    v_fma_f32 v58, v58, v88, -v89
    v_fma_f32 v59, v59, v88, -v89
    v_fma_f32 v60, v60, v88, -v89
    v_fma_f32 v61, v61, v88, -v89
    v_fma_f32 v62, v62, v88, -v89
    v_fma_f32 v63, v63, v88, -v89
    v_fma_f32 v64, v64, v88, -v89
    v_fma_f32 v65, v65, v88, -v89
    v_fma_f32 v66, v66, v88, -v89
    v_fma_f32 v67, v67, v88, -v89
    v_lshlrev_b32 v90, 16, v68
    v_lshlrev_b32 v91, 16, v72
    v_lshlrev_b32 v92, 16, v76
    v_lshlrev_b32 v93, 16, v80
    v_mul_f32 v92, v60, v92
    v_mul_f32 v93, v52, v93
    v_fma_f32 v94, v52, v90, -v92
    v_fma_f32 v96, v60, v91, v93
    v_and_b32 v90, 0xffff0000, v68
    v_and_b32 v91, 0xffff0000, v72
    v_and_b32 v92, 0xffff0000, v76
    v_and_b32 v93, 0xffff0000, v80
    v_mul_f32 v92, v61, v92
    v_mul_f32 v93, v53, v93
    v_fma_f32 v95, v53, v90, -v92
    v_fma_f32 v97, v61, v91, v93
    v_cvt_pk_bf16_f32 v112, v94, v95
    v_cvt_pk_bf16_f32 v114, v96, v97
    v_lshlrev_b32 v90, 16, v69
    v_lshlrev_b32 v91, 16, v73
    v_lshlrev_b32 v92, 16, v77
    v_lshlrev_b32 v93, 16, v81
    v_mul_f32 v92, v62, v92
    s_barrier
    v_mul_f32 v93, v54, v93
    v_fma_f32 v94, v54, v90, -v92
    v_fma_f32 v96, v62, v91, v93
    v_and_b32 v90, 0xffff0000, v69
    v_and_b32 v91, 0xffff0000, v73
    v_and_b32 v92, 0xffff0000, v77
    v_and_b32 v93, 0xffff0000, v81
    v_mul_f32 v92, v63, v92
    v_mul_f32 v93, v55, v93
    v_fma_f32 v95, v55, v90, -v92
    v_fma_f32 v97, v63, v91, v93
    v_cvt_pk_bf16_f32 v113, v94, v95
    v_cvt_pk_bf16_f32 v115, v96, v97
    v_lshlrev_b32 v90, 16, v70
    v_lshlrev_b32 v91, 16, v74
    v_lshlrev_b32 v92, 16, v78
    v_lshlrev_b32 v93, 16, v82
    v_mul_f32 v92, v64, v92
    v_mul_f32 v93, v56, v93
    v_fma_f32 v94, v56, v90, -v92
    v_fma_f32 v96, v64, v91, v93
    v_and_b32 v90, 0xffff0000, v70
    v_and_b32 v91, 0xffff0000, v74
    v_and_b32 v92, 0xffff0000, v78
    v_and_b32 v93, 0xffff0000, v82
    v_mul_f32 v92, v65, v92
    v_mul_f32 v93, v57, v93
    v_fma_f32 v95, v57, v90, -v92
    v_fma_f32 v97, v65, v91, v93
    v_cvt_pk_bf16_f32 v116, v94, v95
    v_cvt_pk_bf16_f32 v118, v96, v97
    v_lshlrev_b32 v90, 16, v71
    v_lshlrev_b32 v91, 16, v75
    v_lshlrev_b32 v92, 16, v79
    v_lshlrev_b32 v93, 16, v83
    v_mul_f32 v92, v66, v92
    v_mul_f32 v93, v58, v93
    v_fma_f32 v94, v58, v90, -v92
    v_fma_f32 v96, v66, v91, v93
    v_and_b32 v90, 0xffff0000, v71
    v_and_b32 v91, 0xffff0000, v75
    v_and_b32 v92, 0xffff0000, v79
    v_and_b32 v93, 0xffff0000, v83
    v_mul_f32 v92, v67, v92
    v_mul_f32 v93, v59, v93
    v_fma_f32 v95, v59, v90, -v92
    v_fma_f32 v97, v67, v91, v93
    v_cvt_pk_bf16_f32 v117, v94, v95
    v_cvt_pk_bf16_f32 v119, v96, v97
    ds_bpermute_b32 v112, v14, v112
    ds_bpermute_b32 v113, v14, v113
    ds_bpermute_b32 v114, v14, v114
    ds_bpermute_b32 v115, v14, v115
    ds_bpermute_b32 v116, v14, v116
    ds_bpermute_b32 v117, v14, v117
    ds_bpermute_b32 v118, v14, v118
    ds_bpermute_b32 v119, v14, v119
    s_waitcnt lgkmcnt(0)
    buffer_store_dwordx4 v[112:115], v8, s[24:27], s90 offen offset:0 sc0 sc1
    buffer_store_dwordx4 v[116:119], v8, s[24:27], s90 offen offset:1024 sc0 sc1
    s_add_u32 s90, s90, 0x20000
    s_barrier
    s_barrier
    s_barrier
    s_waitcnt vmcnt(0)
    s_add_u32 s85, s40, 8
    v_mov_b32 v10, s85
    v_mov_b32 v11, s84
    s_mov_b64 exec, 1
    buffer_store_dword v10, v11, s[72:75], 0 offen sc0 sc1
    s_mov_b64 exec, -1
    s_barrier
    s_barrier
    s_barrier
    s_barrier
    s_barrier
    s_barrier
    s_barrier
    s_barrier
    s_barrier
    s_barrier
    s_branch standalone__kv_cache_quant_pre_rope_vs_post_rope__prompt_kernel_hfin
standalone__kv_cache_quant_pre_rope_vs_post_rope__prompt_kernel_prodv:
    v_and_b32 v3, 15, v2
    v_lshrrev_b32 v4, 4, v2
    v_lshlrev_b32 v5, 11, v4
    v_lshl_add_u32 v5, v3, 4, v5
    v_lshlrev_b32 v7, 3, v4
    v_lshlrev_b32 v8, 4, v2
    s_add_u32 s4, s52, s23
    s_addc_u32 s5, s53, 0
    s_mov_b32 s6, 0x100000
    s_mov_b32 s7, 0x20000
    s_lshl_b32 s28, s21, 12
    s_add_u32 s32, s54, s28
    s_addc_u32 s33, s55, 0
    s_mov_b32 s34, 0x1000
    s_mov_b32 s35, 0x20000
    s_add_u32 s36, s56, s28
    s_addc_u32 s37, s57, 0
    s_mov_b32 s38, 0x1000
    s_mov_b32 s39, 0x20000
    s_lshr_b32 s28, s22, 1
    s_lshl_b32 s28, s28, 5
    s_and_b32 s29, s22, 1
    s_lshl_b32 s87, s28, 9
    s_lshl_b32 s88, s29, 8
    s_add_u32 s87, s87, s88
    s_lshl_b32 s89, s28, 1
    s_lshr_b32 s90, s22, 2
    s_lshl_b32 s90, s90, 15
    s_add_u32 s90, s90, 16384
    s_bfe_u32 s88, s22, 0x10001
    s_lshl_b32 s88, s88, 13
    s_add_u32 s90, s90, s88
    s_lshl_b32 s29, s29, 12
    s_add_u32 s90, s90, s29
    buffer_load_dwordx2 v[48:49], v7, s[32:35], s89 offen offset:0
    buffer_load_dwordx2 v[52:53], v7, s[36:39], s89 offen offset:0
    buffer_load_dwordx2 v[50:51], v7, s[32:35], s89 offen offset:32
    buffer_load_dwordx2 v[54:55], v7, s[36:39], s89 offen offset:32
    s_add_u32 s88, s87, 8192
    buffer_load_dwordx4 v[16:19], v5, s[4:7], s87 offen offset:0 nt
    buffer_load_dwordx4 v[20:23], v5, s[4:7], s87 offen offset:512 nt
    buffer_load_dwordx4 v[24:27], v5, s[4:7], s87 offen offset:1024 nt
    buffer_load_dwordx4 v[28:31], v5, s[4:7], s87 offen offset:1536 nt
    buffer_load_dwordx4 v[32:35], v5, s[4:7], s88 offen offset:0 nt
    buffer_load_dwordx4 v[36:39], v5, s[4:7], s88 offen offset:512 nt
    buffer_load_dwordx4 v[40:43], v5, s[4:7], s88 offen offset:1024 nt
    buffer_load_dwordx4 v[44:47], v5, s[4:7], s88 offen offset:1536 nt
    s_add_u32 s87, s87, 0x20000
    s_add_u32 s89, s89, 512
    s_waitcnt vmcnt(0)
    s_barrier
    v_lshlrev_b32 v96, 16, v48
    v_lshlrev_b32 v104, 16, v52
    v_and_b32 v97, 0xffff0000, v48
    v_and_b32 v105, 0xffff0000, v52
    v_lshlrev_b32 v98, 16, v49
    v_lshlrev_b32 v106, 16, v53
    v_and_b32 v99, 0xffff0000, v49
    v_and_b32 v107, 0xffff0000, v53
    v_lshlrev_b32 v100, 16, v50
    v_lshlrev_b32 v108, 16, v54
    v_and_b32 v101, 0xffff0000, v50
    v_and_b32 v109, 0xffff0000, v54
    v_lshlrev_b32 v102, 16, v51
    v_lshlrev_b32 v110, 16, v55
    v_and_b32 v103, 0xffff0000, v51
    v_and_b32 v111, 0xffff0000, v55
    v_cvt_f32_i32 v16, v16
    v_cvt_f32_i32 v17, v17
    v_cvt_f32_i32 v18, v18
    v_cvt_f32_i32 v19, v19
    v_cvt_f32_i32 v20, v20
    v_cvt_f32_i32 v21, v21
    v_cvt_f32_i32 v22, v22
    v_cvt_f32_i32 v23, v23
    v_cvt_f32_i32 v24, v24
    v_cvt_f32_i32 v25, v25
    v_cvt_f32_i32 v26, v26
    v_cvt_f32_i32 v27, v27
    v_cvt_f32_i32 v28, v28
    v_cvt_f32_i32 v29, v29
    v_cvt_f32_i32 v30, v30
    v_cvt_f32_i32 v31, v31
    v_cvt_f32_i32 v32, v32
    v_cvt_f32_i32 v33, v33
    v_cvt_f32_i32 v34, v34
    v_cvt_f32_i32 v35, v35
    v_cvt_f32_i32 v36, v36
    v_cvt_f32_i32 v37, v37
    v_cvt_f32_i32 v38, v38
    v_cvt_f32_i32 v39, v39
    v_cvt_f32_i32 v40, v40
    v_cvt_f32_i32 v41, v41
    v_cvt_f32_i32 v42, v42
    v_cvt_f32_i32 v43, v43
    v_cvt_f32_i32 v44, v44
    v_cvt_f32_i32 v45, v45
    v_cvt_f32_i32 v46, v46
    v_cvt_f32_i32 v47, v47
    v_mul_f32 v104, v104, v96
    v_mul_f32 v105, v105, v97
    v_mul_f32 v106, v106, v98
    v_mul_f32 v107, v107, v99
    v_mul_f32 v108, v108, v100
    v_mul_f32 v109, v109, v101
    v_mul_f32 v110, v110, v102
    v_mul_f32 v111, v111, v103
    v_fma_f32 v16, v16, v96, -v104
    v_fma_f32 v17, v17, v96, -v104
    v_fma_f32 v18, v18, v96, -v104
    v_fma_f32 v19, v19, v96, -v104
    v_fma_f32 v20, v20, v97, -v105
    v_fma_f32 v21, v21, v97, -v105
    v_fma_f32 v22, v22, v97, -v105
    v_fma_f32 v23, v23, v97, -v105
    v_fma_f32 v24, v24, v98, -v106
    v_fma_f32 v25, v25, v98, -v106
    v_fma_f32 v26, v26, v98, -v106
    v_fma_f32 v27, v27, v98, -v106
    v_fma_f32 v28, v28, v99, -v107
    v_fma_f32 v29, v29, v99, -v107
    v_fma_f32 v30, v30, v99, -v107
    v_fma_f32 v31, v31, v99, -v107
    v_fma_f32 v32, v32, v100, -v108
    v_fma_f32 v33, v33, v100, -v108
    v_fma_f32 v34, v34, v100, -v108
    v_fma_f32 v35, v35, v100, -v108
    v_fma_f32 v36, v36, v101, -v109
    v_fma_f32 v37, v37, v101, -v109
    v_fma_f32 v38, v38, v101, -v109
    v_fma_f32 v39, v39, v101, -v109
    v_fma_f32 v40, v40, v102, -v110
    v_fma_f32 v41, v41, v102, -v110
    v_fma_f32 v42, v42, v102, -v110
    v_fma_f32 v43, v43, v102, -v110
    v_fma_f32 v44, v44, v103, -v111
    v_fma_f32 v45, v45, v103, -v111
    v_fma_f32 v46, v46, v103, -v111
    v_fma_f32 v47, v47, v103, -v111
    v_cvt_pk_bf16_f32 v112, v16, v20
    v_cvt_pk_bf16_f32 v113, v24, v28
    v_cvt_pk_bf16_f32 v114, v32, v36
    v_cvt_pk_bf16_f32 v115, v40, v44
    buffer_store_dwordx4 v[112:115], v8, s[24:27], s90 offen offset:0 sc0 sc1
    v_cvt_pk_bf16_f32 v116, v17, v21
    v_cvt_pk_bf16_f32 v117, v25, v29
    v_cvt_pk_bf16_f32 v118, v33, v37
    v_cvt_pk_bf16_f32 v119, v41, v45
    buffer_store_dwordx4 v[116:119], v8, s[24:27], s90 offen offset:1024 sc0 sc1
    v_cvt_pk_bf16_f32 v120, v18, v22
    v_cvt_pk_bf16_f32 v121, v26, v30
    v_cvt_pk_bf16_f32 v122, v34, v38
    v_cvt_pk_bf16_f32 v123, v42, v46
    buffer_store_dwordx4 v[120:123], v8, s[24:27], s90 offen offset:2048 sc0 sc1
    v_cvt_pk_bf16_f32 v124, v19, v23
    v_cvt_pk_bf16_f32 v125, v27, v31
    v_cvt_pk_bf16_f32 v126, v35, v39
    v_cvt_pk_bf16_f32 v127, v43, v47
    buffer_store_dwordx4 v[124:127], v8, s[24:27], s90 offen offset:3072 sc0 sc1
    s_add_u32 s90, s90, 0x20000
    v_mov_b32 v12, s41
    global_load_dword v13, v12, s[68:69] sc1
    s_waitcnt vmcnt(0)
    v_readfirstlane_b32 s40, v13
    s_cmp_lg_u32 s40, 0
    s_cbranch_scc1 standalone__kv_cache_quant_pre_rope_vs_post_rope__prompt_kernel_v_gotn
standalone__kv_cache_quant_pre_rope_vs_post_rope__prompt_kernel_v_npoll:
    v_mov_b32 v12, s41
    global_load_dword v13, v12, s[68:69] sc1
    s_waitcnt vmcnt(0)
    v_readfirstlane_b32 s40, v13
    s_cmp_eq_u32 s40, 0
    s_cbranch_scc1 standalone__kv_cache_quant_pre_rope_vs_post_rope__prompt_kernel_v_npoll
    s_and_b32 s40, s40, 0xfffffff0
standalone__kv_cache_quant_pre_rope_vs_post_rope__prompt_kernel_v_gotn:
    s_and_b32 s40, s40, 0xfffffff0
    s_add_u32 s85, s40, 1
    v_mov_b32 v10, s85
    v_mov_b32 v11, s84
    s_mov_b64 exec, 1
    buffer_store_dword v10, v11, s[72:75], 0 offen sc0 sc1
    s_mov_b64 exec, -1
    buffer_load_dwordx2 v[88:89], v7, s[32:35], s89 offen offset:0
    buffer_load_dwordx2 v[92:93], v7, s[36:39], s89 offen offset:0
    buffer_load_dwordx2 v[90:91], v7, s[32:35], s89 offen offset:32
    buffer_load_dwordx2 v[94:95], v7, s[36:39], s89 offen offset:32
    s_add_u32 s88, s87, 8192
    buffer_load_dwordx4 v[56:59], v5, s[4:7], s87 offen offset:0 nt
    buffer_load_dwordx4 v[60:63], v5, s[4:7], s87 offen offset:512 nt
    buffer_load_dwordx4 v[64:67], v5, s[4:7], s87 offen offset:1024 nt
    buffer_load_dwordx4 v[68:71], v5, s[4:7], s87 offen offset:1536 nt
    buffer_load_dwordx4 v[72:75], v5, s[4:7], s88 offen offset:0 nt
    buffer_load_dwordx4 v[76:79], v5, s[4:7], s88 offen offset:512 nt
    buffer_load_dwordx4 v[80:83], v5, s[4:7], s88 offen offset:1024 nt
    buffer_load_dwordx4 v[84:87], v5, s[4:7], s88 offen offset:1536 nt
    s_add_u32 s87, s87, 0x20000
    s_add_u32 s89, s89, 512
    s_barrier
    s_waitcnt vmcnt(0)
    v_lshlrev_b32 v96, 16, v88
    v_lshlrev_b32 v104, 16, v92
    v_and_b32 v97, 0xffff0000, v88
    v_and_b32 v105, 0xffff0000, v92
    v_lshlrev_b32 v98, 16, v89
    v_lshlrev_b32 v106, 16, v93
    v_and_b32 v99, 0xffff0000, v89
    v_and_b32 v107, 0xffff0000, v93
    v_lshlrev_b32 v100, 16, v90
    v_lshlrev_b32 v108, 16, v94
    v_and_b32 v101, 0xffff0000, v90
    v_and_b32 v109, 0xffff0000, v94
    v_lshlrev_b32 v102, 16, v91
    v_lshlrev_b32 v110, 16, v95
    v_and_b32 v103, 0xffff0000, v91
    v_and_b32 v111, 0xffff0000, v95
    v_cvt_f32_i32 v56, v56
    v_cvt_f32_i32 v57, v57
    v_cvt_f32_i32 v58, v58
    v_cvt_f32_i32 v59, v59
    v_cvt_f32_i32 v60, v60
    v_cvt_f32_i32 v61, v61
    v_cvt_f32_i32 v62, v62
    v_cvt_f32_i32 v63, v63
    v_cvt_f32_i32 v64, v64
    v_cvt_f32_i32 v65, v65
    v_cvt_f32_i32 v66, v66
    v_cvt_f32_i32 v67, v67
    v_cvt_f32_i32 v68, v68
    v_cvt_f32_i32 v69, v69
    v_cvt_f32_i32 v70, v70
    v_cvt_f32_i32 v71, v71
    v_cvt_f32_i32 v72, v72
    v_cvt_f32_i32 v73, v73
    v_cvt_f32_i32 v74, v74
    v_cvt_f32_i32 v75, v75
    v_cvt_f32_i32 v76, v76
    v_cvt_f32_i32 v77, v77
    v_cvt_f32_i32 v78, v78
    v_cvt_f32_i32 v79, v79
    v_cvt_f32_i32 v80, v80
    v_cvt_f32_i32 v81, v81
    v_cvt_f32_i32 v82, v82
    v_cvt_f32_i32 v83, v83
    v_cvt_f32_i32 v84, v84
    v_cvt_f32_i32 v85, v85
    v_cvt_f32_i32 v86, v86
    v_cvt_f32_i32 v87, v87
    v_mul_f32 v104, v104, v96
    v_mul_f32 v105, v105, v97
    v_mul_f32 v106, v106, v98
    v_mul_f32 v107, v107, v99
    v_mul_f32 v108, v108, v100
    v_mul_f32 v109, v109, v101
    v_mul_f32 v110, v110, v102
    v_mul_f32 v111, v111, v103
    v_fma_f32 v56, v56, v96, -v104
    v_fma_f32 v57, v57, v96, -v104
    v_fma_f32 v58, v58, v96, -v104
    v_fma_f32 v59, v59, v96, -v104
    v_fma_f32 v60, v60, v97, -v105
    v_fma_f32 v61, v61, v97, -v105
    v_fma_f32 v62, v62, v97, -v105
    v_fma_f32 v63, v63, v97, -v105
    v_fma_f32 v64, v64, v98, -v106
    v_fma_f32 v65, v65, v98, -v106
    v_fma_f32 v66, v66, v98, -v106
    v_fma_f32 v67, v67, v98, -v106
    v_fma_f32 v68, v68, v99, -v107
    v_fma_f32 v69, v69, v99, -v107
    v_fma_f32 v70, v70, v99, -v107
    v_fma_f32 v71, v71, v99, -v107
    v_fma_f32 v72, v72, v100, -v108
    v_fma_f32 v73, v73, v100, -v108
    v_fma_f32 v74, v74, v100, -v108
    v_fma_f32 v75, v75, v100, -v108
    v_fma_f32 v76, v76, v101, -v109
    v_fma_f32 v77, v77, v101, -v109
    v_fma_f32 v78, v78, v101, -v109
    v_fma_f32 v79, v79, v101, -v109
    v_fma_f32 v80, v80, v102, -v110
    v_fma_f32 v81, v81, v102, -v110
    v_fma_f32 v82, v82, v102, -v110
    v_fma_f32 v83, v83, v102, -v110
    v_fma_f32 v84, v84, v103, -v111
    v_fma_f32 v85, v85, v103, -v111
    v_fma_f32 v86, v86, v103, -v111
    v_fma_f32 v87, v87, v103, -v111
    v_cvt_pk_bf16_f32 v128, v56, v60
    v_cvt_pk_bf16_f32 v129, v64, v68
    v_cvt_pk_bf16_f32 v130, v72, v76
    v_cvt_pk_bf16_f32 v131, v80, v84
    buffer_store_dwordx4 v[128:131], v8, s[24:27], s90 offen offset:0 sc0 sc1
    v_cvt_pk_bf16_f32 v132, v57, v61
    v_cvt_pk_bf16_f32 v133, v65, v69
    v_cvt_pk_bf16_f32 v134, v73, v77
    v_cvt_pk_bf16_f32 v135, v81, v85
    buffer_store_dwordx4 v[132:135], v8, s[24:27], s90 offen offset:1024 sc0 sc1
    v_cvt_pk_bf16_f32 v136, v58, v62
    v_cvt_pk_bf16_f32 v137, v66, v70
    v_cvt_pk_bf16_f32 v138, v74, v78
    v_cvt_pk_bf16_f32 v139, v82, v86
    buffer_store_dwordx4 v[136:139], v8, s[24:27], s90 offen offset:2048 sc0 sc1
    v_cvt_pk_bf16_f32 v140, v59, v63
    v_cvt_pk_bf16_f32 v141, v67, v71
    v_cvt_pk_bf16_f32 v142, v75, v79
    v_cvt_pk_bf16_f32 v143, v83, v87
    buffer_store_dwordx4 v[140:143], v8, s[24:27], s90 offen offset:3072 sc0 sc1
    s_add_u32 s90, s90, 0x20000
    s_waitcnt vmcnt(0)
    s_add_u32 s85, s40, 2
    v_mov_b32 v10, s85
    v_mov_b32 v11, s84
    s_mov_b64 exec, 1
    buffer_store_dword v10, v11, s[72:75], 0 offen sc0 sc1
    s_mov_b64 exec, -1
    s_setprio 0
    buffer_load_dwordx2 v[48:49], v7, s[32:35], s89 offen offset:0
    buffer_load_dwordx2 v[52:53], v7, s[36:39], s89 offen offset:0
    buffer_load_dwordx2 v[50:51], v7, s[32:35], s89 offen offset:32
    buffer_load_dwordx2 v[54:55], v7, s[36:39], s89 offen offset:32
    s_add_u32 s88, s87, 8192
    buffer_load_dwordx4 v[16:19], v5, s[4:7], s87 offen offset:0 nt
    buffer_load_dwordx4 v[20:23], v5, s[4:7], s87 offen offset:512 nt
    buffer_load_dwordx4 v[24:27], v5, s[4:7], s87 offen offset:1024 nt
    buffer_load_dwordx4 v[28:31], v5, s[4:7], s87 offen offset:1536 nt
    buffer_load_dwordx4 v[32:35], v5, s[4:7], s88 offen offset:0 nt
    buffer_load_dwordx4 v[36:39], v5, s[4:7], s88 offen offset:512 nt
    buffer_load_dwordx4 v[40:43], v5, s[4:7], s88 offen offset:1024 nt
    buffer_load_dwordx4 v[44:47], v5, s[4:7], s88 offen offset:1536 nt
    s_add_u32 s87, s87, 0x20000
    s_add_u32 s89, s89, 512
    s_barrier
    s_barrier
    s_waitcnt vmcnt(0)
    v_lshlrev_b32 v96, 16, v48
    v_lshlrev_b32 v104, 16, v52
    v_and_b32 v97, 0xffff0000, v48
    v_and_b32 v105, 0xffff0000, v52
    v_lshlrev_b32 v98, 16, v49
    v_lshlrev_b32 v106, 16, v53
    v_and_b32 v99, 0xffff0000, v49
    v_and_b32 v107, 0xffff0000, v53
    v_lshlrev_b32 v100, 16, v50
    v_lshlrev_b32 v108, 16, v54
    v_and_b32 v101, 0xffff0000, v50
    v_and_b32 v109, 0xffff0000, v54
    v_lshlrev_b32 v102, 16, v51
    v_lshlrev_b32 v110, 16, v55
    v_and_b32 v103, 0xffff0000, v51
    v_and_b32 v111, 0xffff0000, v55
    v_cvt_f32_i32 v16, v16
    v_cvt_f32_i32 v17, v17
    v_cvt_f32_i32 v18, v18
    v_cvt_f32_i32 v19, v19
    v_cvt_f32_i32 v20, v20
    v_cvt_f32_i32 v21, v21
    v_cvt_f32_i32 v22, v22
    v_cvt_f32_i32 v23, v23
    v_cvt_f32_i32 v24, v24
    v_cvt_f32_i32 v25, v25
    v_cvt_f32_i32 v26, v26
    v_cvt_f32_i32 v27, v27
    v_cvt_f32_i32 v28, v28
    v_cvt_f32_i32 v29, v29
    v_cvt_f32_i32 v30, v30
    v_cvt_f32_i32 v31, v31
    v_cvt_f32_i32 v32, v32
    v_cvt_f32_i32 v33, v33
    v_cvt_f32_i32 v34, v34
    v_cvt_f32_i32 v35, v35
    v_cvt_f32_i32 v36, v36
    v_cvt_f32_i32 v37, v37
    v_cvt_f32_i32 v38, v38
    v_cvt_f32_i32 v39, v39
    v_cvt_f32_i32 v40, v40
    v_cvt_f32_i32 v41, v41
    v_cvt_f32_i32 v42, v42
    v_cvt_f32_i32 v43, v43
    v_cvt_f32_i32 v44, v44
    v_cvt_f32_i32 v45, v45
    buffer_load_dwordx2 v[88:89], v7, s[32:35], s89 offen offset:0
    buffer_load_dwordx2 v[92:93], v7, s[36:39], s89 offen offset:0
    buffer_load_dwordx2 v[90:91], v7, s[32:35], s89 offen offset:32
    buffer_load_dwordx2 v[94:95], v7, s[36:39], s89 offen offset:32
    s_add_u32 s88, s87, 8192
    buffer_load_dwordx4 v[56:59], v5, s[4:7], s87 offen offset:0 nt
    buffer_load_dwordx4 v[60:63], v5, s[4:7], s87 offen offset:512 nt
    buffer_load_dwordx4 v[64:67], v5, s[4:7], s87 offen offset:1024 nt
    buffer_load_dwordx4 v[68:71], v5, s[4:7], s87 offen offset:1536 nt
    buffer_load_dwordx4 v[72:75], v5, s[4:7], s88 offen offset:0 nt
    buffer_load_dwordx4 v[76:79], v5, s[4:7], s88 offen offset:512 nt
    buffer_load_dwordx4 v[80:83], v5, s[4:7], s88 offen offset:1024 nt
    buffer_load_dwordx4 v[84:87], v5, s[4:7], s88 offen offset:1536 nt
    s_add_u32 s87, s87, 0x20000
    s_add_u32 s89, s89, 512
    s_barrier
    v_cvt_f32_i32 v46, v46
    v_cvt_f32_i32 v47, v47
    v_mul_f32 v104, v104, v96
    v_mul_f32 v105, v105, v97
    v_mul_f32 v106, v106, v98
    v_mul_f32 v107, v107, v99
    v_mul_f32 v108, v108, v100
    v_mul_f32 v109, v109, v101
    v_mul_f32 v110, v110, v102
    v_mul_f32 v111, v111, v103
    v_fma_f32 v16, v16, v96, -v104
    v_fma_f32 v17, v17, v96, -v104
    v_fma_f32 v18, v18, v96, -v104
    v_fma_f32 v19, v19, v96, -v104
    v_fma_f32 v20, v20, v97, -v105
    v_fma_f32 v21, v21, v97, -v105
    v_fma_f32 v22, v22, v97, -v105
    v_fma_f32 v23, v23, v97, -v105
    v_fma_f32 v24, v24, v98, -v106
    v_fma_f32 v25, v25, v98, -v106
    v_fma_f32 v26, v26, v98, -v106
    v_fma_f32 v27, v27, v98, -v106
    v_fma_f32 v28, v28, v99, -v107
    v_fma_f32 v29, v29, v99, -v107
    v_fma_f32 v30, v30, v99, -v107
    v_fma_f32 v31, v31, v99, -v107
    v_fma_f32 v32, v32, v100, -v108
    v_fma_f32 v33, v33, v100, -v108
    v_fma_f32 v34, v34, v100, -v108
    v_fma_f32 v35, v35, v100, -v108
    v_fma_f32 v36, v36, v101, -v109
    v_fma_f32 v37, v37, v101, -v109
    v_fma_f32 v38, v38, v101, -v109
    v_fma_f32 v39, v39, v101, -v109
    v_fma_f32 v40, v40, v102, -v110
    v_fma_f32 v41, v41, v102, -v110
    v_fma_f32 v42, v42, v102, -v110
    v_fma_f32 v43, v43, v102, -v110
    v_fma_f32 v44, v44, v103, -v111
    v_fma_f32 v45, v45, v103, -v111
    v_fma_f32 v46, v46, v103, -v111
    v_fma_f32 v47, v47, v103, -v111
    v_cvt_pk_bf16_f32 v112, v16, v20
    v_cvt_pk_bf16_f32 v113, v24, v28
    v_cvt_pk_bf16_f32 v114, v32, v36
    v_cvt_pk_bf16_f32 v115, v40, v44
    buffer_store_dwordx4 v[112:115], v8, s[24:27], s90 offen offset:0 sc0 sc1
    v_cvt_pk_bf16_f32 v116, v17, v21
    v_cvt_pk_bf16_f32 v117, v25, v29
    v_cvt_pk_bf16_f32 v118, v33, v37
    v_cvt_pk_bf16_f32 v119, v41, v45
    buffer_store_dwordx4 v[116:119], v8, s[24:27], s90 offen offset:1024 sc0 sc1
    v_cvt_pk_bf16_f32 v120, v18, v22
    v_cvt_pk_bf16_f32 v121, v26, v30
    v_cvt_pk_bf16_f32 v122, v34, v38
    v_cvt_pk_bf16_f32 v123, v42, v46
    buffer_store_dwordx4 v[120:123], v8, s[24:27], s90 offen offset:2048 sc0 sc1
    v_cvt_pk_bf16_f32 v124, v19, v23
    v_cvt_pk_bf16_f32 v125, v27, v31
    v_cvt_pk_bf16_f32 v126, v35, v39
    v_cvt_pk_bf16_f32 v127, v43, v47
    buffer_store_dwordx4 v[124:127], v8, s[24:27], s90 offen offset:3072 sc0 sc1
    s_add_u32 s90, s90, 0x20000
    s_barrier
    s_barrier
    s_waitcnt vmcnt(0)
    s_add_u32 s85, s40, 3
    v_mov_b32 v10, s85
    v_mov_b32 v11, s84
    s_mov_b64 exec, 1
    buffer_store_dword v10, v11, s[72:75], 0 offen sc0 sc1
    s_mov_b64 exec, -1
    v_lshlrev_b32 v96, 16, v88
    v_lshlrev_b32 v104, 16, v92
    v_and_b32 v97, 0xffff0000, v88
    v_and_b32 v105, 0xffff0000, v92
    v_lshlrev_b32 v98, 16, v89
    v_lshlrev_b32 v106, 16, v93
    v_and_b32 v99, 0xffff0000, v89
    v_and_b32 v107, 0xffff0000, v93
    v_lshlrev_b32 v100, 16, v90
    v_lshlrev_b32 v108, 16, v94
    v_and_b32 v101, 0xffff0000, v90
    v_and_b32 v109, 0xffff0000, v94
    v_lshlrev_b32 v102, 16, v91
    v_lshlrev_b32 v110, 16, v95
    v_and_b32 v103, 0xffff0000, v91
    v_and_b32 v111, 0xffff0000, v95
    v_cvt_f32_i32 v56, v56
    v_cvt_f32_i32 v57, v57
    v_cvt_f32_i32 v58, v58
    v_cvt_f32_i32 v59, v59
    v_cvt_f32_i32 v60, v60
    v_cvt_f32_i32 v61, v61
    v_cvt_f32_i32 v62, v62
    v_cvt_f32_i32 v63, v63
    v_cvt_f32_i32 v64, v64
    v_cvt_f32_i32 v65, v65
    v_cvt_f32_i32 v66, v66
    v_cvt_f32_i32 v67, v67
    v_cvt_f32_i32 v68, v68
    v_cvt_f32_i32 v69, v69
    v_cvt_f32_i32 v70, v70
    v_cvt_f32_i32 v71, v71
    v_cvt_f32_i32 v72, v72
    v_cvt_f32_i32 v73, v73
    v_cvt_f32_i32 v74, v74
    v_cvt_f32_i32 v75, v75
    v_cvt_f32_i32 v76, v76
    v_cvt_f32_i32 v77, v77
    v_cvt_f32_i32 v78, v78
    v_cvt_f32_i32 v79, v79
    v_cvt_f32_i32 v80, v80
    v_cvt_f32_i32 v81, v81
    v_cvt_f32_i32 v82, v82
    v_cvt_f32_i32 v83, v83
    v_cvt_f32_i32 v84, v84
    v_cvt_f32_i32 v85, v85
    buffer_load_dwordx2 v[48:49], v7, s[32:35], s89 offen offset:0
    buffer_load_dwordx2 v[52:53], v7, s[36:39], s89 offen offset:0
    buffer_load_dwordx2 v[50:51], v7, s[32:35], s89 offen offset:32
    buffer_load_dwordx2 v[54:55], v7, s[36:39], s89 offen offset:32
    s_add_u32 s88, s87, 8192
    buffer_load_dwordx4 v[16:19], v5, s[4:7], s87 offen offset:0 nt
    buffer_load_dwordx4 v[20:23], v5, s[4:7], s87 offen offset:512 nt
    buffer_load_dwordx4 v[24:27], v5, s[4:7], s87 offen offset:1024 nt
    buffer_load_dwordx4 v[28:31], v5, s[4:7], s87 offen offset:1536 nt
    buffer_load_dwordx4 v[32:35], v5, s[4:7], s88 offen offset:0 nt
    buffer_load_dwordx4 v[36:39], v5, s[4:7], s88 offen offset:512 nt
    buffer_load_dwordx4 v[40:43], v5, s[4:7], s88 offen offset:1024 nt
    buffer_load_dwordx4 v[44:47], v5, s[4:7], s88 offen offset:1536 nt
    s_add_u32 s87, s87, 0x20000
    s_add_u32 s89, s89, 512
    s_barrier
    v_cvt_f32_i32 v86, v86
    v_cvt_f32_i32 v87, v87
    v_mul_f32 v104, v104, v96
    v_mul_f32 v105, v105, v97
    v_mul_f32 v106, v106, v98
    v_mul_f32 v107, v107, v99
    v_mul_f32 v108, v108, v100
    v_mul_f32 v109, v109, v101
    v_mul_f32 v110, v110, v102
    v_mul_f32 v111, v111, v103
    v_fma_f32 v56, v56, v96, -v104
    v_fma_f32 v57, v57, v96, -v104
    v_fma_f32 v58, v58, v96, -v104
    v_fma_f32 v59, v59, v96, -v104
    v_fma_f32 v60, v60, v97, -v105
    v_fma_f32 v61, v61, v97, -v105
    v_fma_f32 v62, v62, v97, -v105
    v_fma_f32 v63, v63, v97, -v105
    v_fma_f32 v64, v64, v98, -v106
    v_fma_f32 v65, v65, v98, -v106
    v_fma_f32 v66, v66, v98, -v106
    v_fma_f32 v67, v67, v98, -v106
    v_fma_f32 v68, v68, v99, -v107
    v_fma_f32 v69, v69, v99, -v107
    v_fma_f32 v70, v70, v99, -v107
    v_fma_f32 v71, v71, v99, -v107
    v_fma_f32 v72, v72, v100, -v108
    v_fma_f32 v73, v73, v100, -v108
    v_fma_f32 v74, v74, v100, -v108
    v_fma_f32 v75, v75, v100, -v108
    v_fma_f32 v76, v76, v101, -v109
    v_fma_f32 v77, v77, v101, -v109
    v_fma_f32 v78, v78, v101, -v109
    v_fma_f32 v79, v79, v101, -v109
    v_fma_f32 v80, v80, v102, -v110
    v_fma_f32 v81, v81, v102, -v110
    v_fma_f32 v82, v82, v102, -v110
    v_fma_f32 v83, v83, v102, -v110
    v_fma_f32 v84, v84, v103, -v111
    v_fma_f32 v85, v85, v103, -v111
    v_fma_f32 v86, v86, v103, -v111
    v_fma_f32 v87, v87, v103, -v111
    v_cvt_pk_bf16_f32 v128, v56, v60
    v_cvt_pk_bf16_f32 v129, v64, v68
    v_cvt_pk_bf16_f32 v130, v72, v76
    v_cvt_pk_bf16_f32 v131, v80, v84
    buffer_store_dwordx4 v[128:131], v8, s[24:27], s90 offen offset:0 sc0 sc1
    v_cvt_pk_bf16_f32 v132, v57, v61
    v_cvt_pk_bf16_f32 v133, v65, v69
    v_cvt_pk_bf16_f32 v134, v73, v77
    v_cvt_pk_bf16_f32 v135, v81, v85
    buffer_store_dwordx4 v[132:135], v8, s[24:27], s90 offen offset:1024 sc0 sc1
    v_cvt_pk_bf16_f32 v136, v58, v62
    v_cvt_pk_bf16_f32 v137, v66, v70
    v_cvt_pk_bf16_f32 v138, v74, v78
    v_cvt_pk_bf16_f32 v139, v82, v86
    buffer_store_dwordx4 v[136:139], v8, s[24:27], s90 offen offset:2048 sc0 sc1
    v_cvt_pk_bf16_f32 v140, v59, v63
    v_cvt_pk_bf16_f32 v141, v67, v71
    v_cvt_pk_bf16_f32 v142, v75, v79
    v_cvt_pk_bf16_f32 v143, v83, v87
    buffer_store_dwordx4 v[140:143], v8, s[24:27], s90 offen offset:3072 sc0 sc1
    s_add_u32 s90, s90, 0x20000
    s_barrier
    s_barrier
    s_waitcnt vmcnt(0)
    s_add_u32 s85, s40, 4
    v_mov_b32 v10, s85
    v_mov_b32 v11, s84
    s_mov_b64 exec, 1
    buffer_store_dword v10, v11, s[72:75], 0 offen sc0 sc1
    s_mov_b64 exec, -1
    v_lshlrev_b32 v96, 16, v48
    v_lshlrev_b32 v104, 16, v52
    v_and_b32 v97, 0xffff0000, v48
    v_and_b32 v105, 0xffff0000, v52
    v_lshlrev_b32 v98, 16, v49
    v_lshlrev_b32 v106, 16, v53
    v_and_b32 v99, 0xffff0000, v49
    v_and_b32 v107, 0xffff0000, v53
    v_lshlrev_b32 v100, 16, v50
    v_lshlrev_b32 v108, 16, v54
    v_and_b32 v101, 0xffff0000, v50
    v_and_b32 v109, 0xffff0000, v54
    v_lshlrev_b32 v102, 16, v51
    v_lshlrev_b32 v110, 16, v55
    v_and_b32 v103, 0xffff0000, v51
    v_and_b32 v111, 0xffff0000, v55
    v_cvt_f32_i32 v16, v16
    v_cvt_f32_i32 v17, v17
    v_cvt_f32_i32 v18, v18
    v_cvt_f32_i32 v19, v19
    v_cvt_f32_i32 v20, v20
    v_cvt_f32_i32 v21, v21
    v_cvt_f32_i32 v22, v22
    v_cvt_f32_i32 v23, v23
    v_cvt_f32_i32 v24, v24
    v_cvt_f32_i32 v25, v25
    v_cvt_f32_i32 v26, v26
    v_cvt_f32_i32 v27, v27
    v_cvt_f32_i32 v28, v28
    v_cvt_f32_i32 v29, v29
    v_cvt_f32_i32 v30, v30
    v_cvt_f32_i32 v31, v31
    v_cvt_f32_i32 v32, v32
    v_cvt_f32_i32 v33, v33
    v_cvt_f32_i32 v34, v34
    v_cvt_f32_i32 v35, v35
    v_cvt_f32_i32 v36, v36
    v_cvt_f32_i32 v37, v37
    v_cvt_f32_i32 v38, v38
    v_cvt_f32_i32 v39, v39
    v_cvt_f32_i32 v40, v40
    v_cvt_f32_i32 v41, v41
    v_cvt_f32_i32 v42, v42
    v_cvt_f32_i32 v43, v43
    v_cvt_f32_i32 v44, v44
    v_cvt_f32_i32 v45, v45
    buffer_load_dwordx2 v[88:89], v7, s[32:35], s89 offen offset:0
    buffer_load_dwordx2 v[92:93], v7, s[36:39], s89 offen offset:0
    buffer_load_dwordx2 v[90:91], v7, s[32:35], s89 offen offset:32
    buffer_load_dwordx2 v[94:95], v7, s[36:39], s89 offen offset:32
    s_add_u32 s88, s87, 8192
    buffer_load_dwordx4 v[56:59], v5, s[4:7], s87 offen offset:0 nt
    buffer_load_dwordx4 v[60:63], v5, s[4:7], s87 offen offset:512 nt
    buffer_load_dwordx4 v[64:67], v5, s[4:7], s87 offen offset:1024 nt
    buffer_load_dwordx4 v[68:71], v5, s[4:7], s87 offen offset:1536 nt
    buffer_load_dwordx4 v[72:75], v5, s[4:7], s88 offen offset:0 nt
    buffer_load_dwordx4 v[76:79], v5, s[4:7], s88 offen offset:512 nt
    buffer_load_dwordx4 v[80:83], v5, s[4:7], s88 offen offset:1024 nt
    buffer_load_dwordx4 v[84:87], v5, s[4:7], s88 offen offset:1536 nt
    s_add_u32 s87, s87, 0x20000
    s_add_u32 s89, s89, 512
    s_barrier
    v_cvt_f32_i32 v46, v46
    v_cvt_f32_i32 v47, v47
    v_mul_f32 v104, v104, v96
    v_mul_f32 v105, v105, v97
    v_mul_f32 v106, v106, v98
    v_mul_f32 v107, v107, v99
    v_mul_f32 v108, v108, v100
    v_mul_f32 v109, v109, v101
    v_mul_f32 v110, v110, v102
    v_mul_f32 v111, v111, v103
    v_fma_f32 v16, v16, v96, -v104
    v_fma_f32 v17, v17, v96, -v104
    v_fma_f32 v18, v18, v96, -v104
    v_fma_f32 v19, v19, v96, -v104
    v_fma_f32 v20, v20, v97, -v105
    v_fma_f32 v21, v21, v97, -v105
    v_fma_f32 v22, v22, v97, -v105
    v_fma_f32 v23, v23, v97, -v105
    v_fma_f32 v24, v24, v98, -v106
    v_fma_f32 v25, v25, v98, -v106
    v_fma_f32 v26, v26, v98, -v106
    v_fma_f32 v27, v27, v98, -v106
    v_fma_f32 v28, v28, v99, -v107
    v_fma_f32 v29, v29, v99, -v107
    v_fma_f32 v30, v30, v99, -v107
    v_fma_f32 v31, v31, v99, -v107
    v_fma_f32 v32, v32, v100, -v108
    v_fma_f32 v33, v33, v100, -v108
    v_fma_f32 v34, v34, v100, -v108
    v_fma_f32 v35, v35, v100, -v108
    v_fma_f32 v36, v36, v101, -v109
    v_fma_f32 v37, v37, v101, -v109
    v_fma_f32 v38, v38, v101, -v109
    v_fma_f32 v39, v39, v101, -v109
    v_fma_f32 v40, v40, v102, -v110
    v_fma_f32 v41, v41, v102, -v110
    v_fma_f32 v42, v42, v102, -v110
    v_fma_f32 v43, v43, v102, -v110
    v_fma_f32 v44, v44, v103, -v111
    v_fma_f32 v45, v45, v103, -v111
    v_fma_f32 v46, v46, v103, -v111
    v_fma_f32 v47, v47, v103, -v111
    v_cvt_pk_bf16_f32 v112, v16, v20
    v_cvt_pk_bf16_f32 v113, v24, v28
    v_cvt_pk_bf16_f32 v114, v32, v36
    v_cvt_pk_bf16_f32 v115, v40, v44
    buffer_store_dwordx4 v[112:115], v8, s[24:27], s90 offen offset:0 sc0 sc1
    v_cvt_pk_bf16_f32 v116, v17, v21
    v_cvt_pk_bf16_f32 v117, v25, v29
    v_cvt_pk_bf16_f32 v118, v33, v37
    v_cvt_pk_bf16_f32 v119, v41, v45
    buffer_store_dwordx4 v[116:119], v8, s[24:27], s90 offen offset:1024 sc0 sc1
    v_cvt_pk_bf16_f32 v120, v18, v22
    v_cvt_pk_bf16_f32 v121, v26, v30
    v_cvt_pk_bf16_f32 v122, v34, v38
    v_cvt_pk_bf16_f32 v123, v42, v46
    buffer_store_dwordx4 v[120:123], v8, s[24:27], s90 offen offset:2048 sc0 sc1
    v_cvt_pk_bf16_f32 v124, v19, v23
    v_cvt_pk_bf16_f32 v125, v27, v31
    v_cvt_pk_bf16_f32 v126, v35, v39
    v_cvt_pk_bf16_f32 v127, v43, v47
    buffer_store_dwordx4 v[124:127], v8, s[24:27], s90 offen offset:3072 sc0 sc1
    s_add_u32 s90, s90, 0x20000
    s_barrier
    s_barrier
    s_barrier
    s_waitcnt vmcnt(0)
    s_add_u32 s85, s40, 5
    v_mov_b32 v10, s85
    v_mov_b32 v11, s84
    s_mov_b64 exec, 1
    buffer_store_dword v10, v11, s[72:75], 0 offen sc0 sc1
    s_mov_b64 exec, -1
    v_lshlrev_b32 v96, 16, v88
    v_lshlrev_b32 v104, 16, v92
    v_and_b32 v97, 0xffff0000, v88
    v_and_b32 v105, 0xffff0000, v92
    v_lshlrev_b32 v98, 16, v89
    v_lshlrev_b32 v106, 16, v93
    v_and_b32 v99, 0xffff0000, v89
    v_and_b32 v107, 0xffff0000, v93
    v_lshlrev_b32 v100, 16, v90
    v_lshlrev_b32 v108, 16, v94
    v_and_b32 v101, 0xffff0000, v90
    v_and_b32 v109, 0xffff0000, v94
    v_lshlrev_b32 v102, 16, v91
    v_lshlrev_b32 v110, 16, v95
    v_and_b32 v103, 0xffff0000, v91
    v_and_b32 v111, 0xffff0000, v95
    v_cvt_f32_i32 v56, v56
    v_cvt_f32_i32 v57, v57
    v_cvt_f32_i32 v58, v58
    v_cvt_f32_i32 v59, v59
    v_cvt_f32_i32 v60, v60
    v_cvt_f32_i32 v61, v61
    v_cvt_f32_i32 v62, v62
    v_cvt_f32_i32 v63, v63
    v_cvt_f32_i32 v64, v64
    v_cvt_f32_i32 v65, v65
    v_cvt_f32_i32 v66, v66
    v_cvt_f32_i32 v67, v67
    v_cvt_f32_i32 v68, v68
    v_cvt_f32_i32 v69, v69
    v_cvt_f32_i32 v70, v70
    v_cvt_f32_i32 v71, v71
    v_cvt_f32_i32 v72, v72
    v_cvt_f32_i32 v73, v73
    v_cvt_f32_i32 v74, v74
    v_cvt_f32_i32 v75, v75
    v_cvt_f32_i32 v76, v76
    v_cvt_f32_i32 v77, v77
    v_cvt_f32_i32 v78, v78
    v_cvt_f32_i32 v79, v79
    v_cvt_f32_i32 v80, v80
    v_cvt_f32_i32 v81, v81
    v_cvt_f32_i32 v82, v82
    v_cvt_f32_i32 v83, v83
    v_cvt_f32_i32 v84, v84
    v_cvt_f32_i32 v85, v85
    buffer_load_dwordx2 v[48:49], v7, s[32:35], s89 offen offset:0
    buffer_load_dwordx2 v[52:53], v7, s[36:39], s89 offen offset:0
    buffer_load_dwordx2 v[50:51], v7, s[32:35], s89 offen offset:32
    buffer_load_dwordx2 v[54:55], v7, s[36:39], s89 offen offset:32
    s_add_u32 s88, s87, 8192
    buffer_load_dwordx4 v[16:19], v5, s[4:7], s87 offen offset:0 nt
    buffer_load_dwordx4 v[20:23], v5, s[4:7], s87 offen offset:512 nt
    buffer_load_dwordx4 v[24:27], v5, s[4:7], s87 offen offset:1024 nt
    buffer_load_dwordx4 v[28:31], v5, s[4:7], s87 offen offset:1536 nt
    buffer_load_dwordx4 v[32:35], v5, s[4:7], s88 offen offset:0 nt
    buffer_load_dwordx4 v[36:39], v5, s[4:7], s88 offen offset:512 nt
    buffer_load_dwordx4 v[40:43], v5, s[4:7], s88 offen offset:1024 nt
    buffer_load_dwordx4 v[44:47], v5, s[4:7], s88 offen offset:1536 nt
    s_add_u32 s87, s87, 0x20000
    s_add_u32 s89, s89, 512
    s_barrier
    v_cvt_f32_i32 v86, v86
    v_cvt_f32_i32 v87, v87
    v_mul_f32 v104, v104, v96
    v_mul_f32 v105, v105, v97
    v_mul_f32 v106, v106, v98
    v_mul_f32 v107, v107, v99
    v_mul_f32 v108, v108, v100
    v_mul_f32 v109, v109, v101
    v_mul_f32 v110, v110, v102
    v_mul_f32 v111, v111, v103
    v_fma_f32 v56, v56, v96, -v104
    v_fma_f32 v57, v57, v96, -v104
    v_fma_f32 v58, v58, v96, -v104
    v_fma_f32 v59, v59, v96, -v104
    v_fma_f32 v60, v60, v97, -v105
    v_fma_f32 v61, v61, v97, -v105
    v_fma_f32 v62, v62, v97, -v105
    v_fma_f32 v63, v63, v97, -v105
    v_fma_f32 v64, v64, v98, -v106
    v_fma_f32 v65, v65, v98, -v106
    v_fma_f32 v66, v66, v98, -v106
    v_fma_f32 v67, v67, v98, -v106
    v_fma_f32 v68, v68, v99, -v107
    v_fma_f32 v69, v69, v99, -v107
    v_fma_f32 v70, v70, v99, -v107
    v_fma_f32 v71, v71, v99, -v107
    v_fma_f32 v72, v72, v100, -v108
    v_fma_f32 v73, v73, v100, -v108
    v_fma_f32 v74, v74, v100, -v108
    v_fma_f32 v75, v75, v100, -v108
    v_fma_f32 v76, v76, v101, -v109
    v_fma_f32 v77, v77, v101, -v109
    v_fma_f32 v78, v78, v101, -v109
    v_fma_f32 v79, v79, v101, -v109
    v_fma_f32 v80, v80, v102, -v110
    v_fma_f32 v81, v81, v102, -v110
    v_fma_f32 v82, v82, v102, -v110
    v_fma_f32 v83, v83, v102, -v110
    v_fma_f32 v84, v84, v103, -v111
    v_fma_f32 v85, v85, v103, -v111
    v_fma_f32 v86, v86, v103, -v111
    v_fma_f32 v87, v87, v103, -v111
    v_cvt_pk_bf16_f32 v128, v56, v60
    v_cvt_pk_bf16_f32 v129, v64, v68
    v_cvt_pk_bf16_f32 v130, v72, v76
    v_cvt_pk_bf16_f32 v131, v80, v84
    buffer_store_dwordx4 v[128:131], v8, s[24:27], s90 offen offset:0 sc0 sc1
    v_cvt_pk_bf16_f32 v132, v57, v61
    v_cvt_pk_bf16_f32 v133, v65, v69
    v_cvt_pk_bf16_f32 v134, v73, v77
    v_cvt_pk_bf16_f32 v135, v81, v85
    buffer_store_dwordx4 v[132:135], v8, s[24:27], s90 offen offset:1024 sc0 sc1
    v_cvt_pk_bf16_f32 v136, v58, v62
    v_cvt_pk_bf16_f32 v137, v66, v70
    v_cvt_pk_bf16_f32 v138, v74, v78
    v_cvt_pk_bf16_f32 v139, v82, v86
    buffer_store_dwordx4 v[136:139], v8, s[24:27], s90 offen offset:2048 sc0 sc1
    v_cvt_pk_bf16_f32 v140, v59, v63
    v_cvt_pk_bf16_f32 v141, v67, v71
    v_cvt_pk_bf16_f32 v142, v75, v79
    v_cvt_pk_bf16_f32 v143, v83, v87
    buffer_store_dwordx4 v[140:143], v8, s[24:27], s90 offen offset:3072 sc0 sc1
    s_add_u32 s90, s90, 0x20000
    s_barrier
    s_barrier
    s_barrier
    s_waitcnt vmcnt(0)
    s_add_u32 s85, s40, 6
    v_mov_b32 v10, s85
    v_mov_b32 v11, s84
    s_mov_b64 exec, 1
    buffer_store_dword v10, v11, s[72:75], 0 offen sc0 sc1
    s_mov_b64 exec, -1
    v_lshlrev_b32 v96, 16, v48
    v_lshlrev_b32 v104, 16, v52
    v_and_b32 v97, 0xffff0000, v48
    v_and_b32 v105, 0xffff0000, v52
    v_lshlrev_b32 v98, 16, v49
    v_lshlrev_b32 v106, 16, v53
    v_and_b32 v99, 0xffff0000, v49
    v_and_b32 v107, 0xffff0000, v53
    v_lshlrev_b32 v100, 16, v50
    v_lshlrev_b32 v108, 16, v54
    v_and_b32 v101, 0xffff0000, v50
    v_and_b32 v109, 0xffff0000, v54
    v_lshlrev_b32 v102, 16, v51
    v_lshlrev_b32 v110, 16, v55
    v_and_b32 v103, 0xffff0000, v51
    v_and_b32 v111, 0xffff0000, v55
    v_cvt_f32_i32 v16, v16
    v_cvt_f32_i32 v17, v17
    v_cvt_f32_i32 v18, v18
    v_cvt_f32_i32 v19, v19
    v_cvt_f32_i32 v20, v20
    v_cvt_f32_i32 v21, v21
    v_cvt_f32_i32 v22, v22
    v_cvt_f32_i32 v23, v23
    v_cvt_f32_i32 v24, v24
    v_cvt_f32_i32 v25, v25
    v_cvt_f32_i32 v26, v26
    v_cvt_f32_i32 v27, v27
    v_cvt_f32_i32 v28, v28
    v_cvt_f32_i32 v29, v29
    v_cvt_f32_i32 v30, v30
    v_cvt_f32_i32 v31, v31
    v_cvt_f32_i32 v32, v32
    v_cvt_f32_i32 v33, v33
    v_cvt_f32_i32 v34, v34
    v_cvt_f32_i32 v35, v35
    v_cvt_f32_i32 v36, v36
    v_cvt_f32_i32 v37, v37
    v_cvt_f32_i32 v38, v38
    v_cvt_f32_i32 v39, v39
    v_cvt_f32_i32 v40, v40
    v_cvt_f32_i32 v41, v41
    v_cvt_f32_i32 v42, v42
    v_cvt_f32_i32 v43, v43
    v_cvt_f32_i32 v44, v44
    v_cvt_f32_i32 v45, v45
    buffer_load_dwordx2 v[88:89], v7, s[32:35], s89 offen offset:0
    buffer_load_dwordx2 v[92:93], v7, s[36:39], s89 offen offset:0
    buffer_load_dwordx2 v[90:91], v7, s[32:35], s89 offen offset:32
    buffer_load_dwordx2 v[94:95], v7, s[36:39], s89 offen offset:32
    s_add_u32 s88, s87, 8192
    buffer_load_dwordx4 v[56:59], v5, s[4:7], s87 offen offset:0 nt
    buffer_load_dwordx4 v[60:63], v5, s[4:7], s87 offen offset:512 nt
    buffer_load_dwordx4 v[64:67], v5, s[4:7], s87 offen offset:1024 nt
    buffer_load_dwordx4 v[68:71], v5, s[4:7], s87 offen offset:1536 nt
    buffer_load_dwordx4 v[72:75], v5, s[4:7], s88 offen offset:0 nt
    buffer_load_dwordx4 v[76:79], v5, s[4:7], s88 offen offset:512 nt
    buffer_load_dwordx4 v[80:83], v5, s[4:7], s88 offen offset:1024 nt
    buffer_load_dwordx4 v[84:87], v5, s[4:7], s88 offen offset:1536 nt
    s_add_u32 s87, s87, 0x20000
    s_add_u32 s89, s89, 512
    s_barrier
    v_cvt_f32_i32 v46, v46
    v_cvt_f32_i32 v47, v47
    v_mul_f32 v104, v104, v96
    v_mul_f32 v105, v105, v97
    v_mul_f32 v106, v106, v98
    v_mul_f32 v107, v107, v99
    v_mul_f32 v108, v108, v100
    v_mul_f32 v109, v109, v101
    v_mul_f32 v110, v110, v102
    v_mul_f32 v111, v111, v103
    v_fma_f32 v16, v16, v96, -v104
    v_fma_f32 v17, v17, v96, -v104
    v_fma_f32 v18, v18, v96, -v104
    v_fma_f32 v19, v19, v96, -v104
    v_fma_f32 v20, v20, v97, -v105
    v_fma_f32 v21, v21, v97, -v105
    v_fma_f32 v22, v22, v97, -v105
    v_fma_f32 v23, v23, v97, -v105
    v_fma_f32 v24, v24, v98, -v106
    v_fma_f32 v25, v25, v98, -v106
    v_fma_f32 v26, v26, v98, -v106
    v_fma_f32 v27, v27, v98, -v106
    v_fma_f32 v28, v28, v99, -v107
    v_fma_f32 v29, v29, v99, -v107
    v_fma_f32 v30, v30, v99, -v107
    v_fma_f32 v31, v31, v99, -v107
    v_fma_f32 v32, v32, v100, -v108
    v_fma_f32 v33, v33, v100, -v108
    v_fma_f32 v34, v34, v100, -v108
    v_fma_f32 v35, v35, v100, -v108
    v_fma_f32 v36, v36, v101, -v109
    v_fma_f32 v37, v37, v101, -v109
    v_fma_f32 v38, v38, v101, -v109
    v_fma_f32 v39, v39, v101, -v109
    v_fma_f32 v40, v40, v102, -v110
    v_fma_f32 v41, v41, v102, -v110
    v_fma_f32 v42, v42, v102, -v110
    v_fma_f32 v43, v43, v102, -v110
    v_fma_f32 v44, v44, v103, -v111
    v_fma_f32 v45, v45, v103, -v111
    v_fma_f32 v46, v46, v103, -v111
    v_fma_f32 v47, v47, v103, -v111
    v_cvt_pk_bf16_f32 v112, v16, v20
    v_cvt_pk_bf16_f32 v113, v24, v28
    v_cvt_pk_bf16_f32 v114, v32, v36
    v_cvt_pk_bf16_f32 v115, v40, v44
    buffer_store_dwordx4 v[112:115], v8, s[24:27], s90 offen offset:0 sc0 sc1
    v_cvt_pk_bf16_f32 v116, v17, v21
    v_cvt_pk_bf16_f32 v117, v25, v29
    v_cvt_pk_bf16_f32 v118, v33, v37
    v_cvt_pk_bf16_f32 v119, v41, v45
    buffer_store_dwordx4 v[116:119], v8, s[24:27], s90 offen offset:1024 sc0 sc1
    v_cvt_pk_bf16_f32 v120, v18, v22
    v_cvt_pk_bf16_f32 v121, v26, v30
    v_cvt_pk_bf16_f32 v122, v34, v38
    v_cvt_pk_bf16_f32 v123, v42, v46
    buffer_store_dwordx4 v[120:123], v8, s[24:27], s90 offen offset:2048 sc0 sc1
    v_cvt_pk_bf16_f32 v124, v19, v23
    v_cvt_pk_bf16_f32 v125, v27, v31
    v_cvt_pk_bf16_f32 v126, v35, v39
    v_cvt_pk_bf16_f32 v127, v43, v47
    buffer_store_dwordx4 v[124:127], v8, s[24:27], s90 offen offset:3072 sc0 sc1
    s_add_u32 s90, s90, 0x20000
    s_barrier
    s_barrier
    s_barrier
    s_waitcnt vmcnt(0)
    s_add_u32 s85, s40, 7
    v_mov_b32 v10, s85
    v_mov_b32 v11, s84
    s_mov_b64 exec, 1
    buffer_store_dword v10, v11, s[72:75], 0 offen sc0 sc1
    s_mov_b64 exec, -1
    v_lshlrev_b32 v96, 16, v88
    v_lshlrev_b32 v104, 16, v92
    v_and_b32 v97, 0xffff0000, v88
    v_and_b32 v105, 0xffff0000, v92
    v_lshlrev_b32 v98, 16, v89
    v_lshlrev_b32 v106, 16, v93
    v_and_b32 v99, 0xffff0000, v89
    v_and_b32 v107, 0xffff0000, v93
    v_lshlrev_b32 v100, 16, v90
    v_lshlrev_b32 v108, 16, v94
    v_and_b32 v101, 0xffff0000, v90
    v_and_b32 v109, 0xffff0000, v94
    v_lshlrev_b32 v102, 16, v91
    v_lshlrev_b32 v110, 16, v95
    v_and_b32 v103, 0xffff0000, v91
    v_and_b32 v111, 0xffff0000, v95
    v_cvt_f32_i32 v56, v56
    v_cvt_f32_i32 v57, v57
    v_cvt_f32_i32 v58, v58
    v_cvt_f32_i32 v59, v59
    v_cvt_f32_i32 v60, v60
    v_cvt_f32_i32 v61, v61
    v_cvt_f32_i32 v62, v62
    v_cvt_f32_i32 v63, v63
    v_cvt_f32_i32 v64, v64
    v_cvt_f32_i32 v65, v65
    v_cvt_f32_i32 v66, v66
    v_cvt_f32_i32 v67, v67
    v_cvt_f32_i32 v68, v68
    v_cvt_f32_i32 v69, v69
    v_cvt_f32_i32 v70, v70
    v_cvt_f32_i32 v71, v71
    v_cvt_f32_i32 v72, v72
    v_cvt_f32_i32 v73, v73
    v_cvt_f32_i32 v74, v74
    v_cvt_f32_i32 v75, v75
    v_cvt_f32_i32 v76, v76
    v_cvt_f32_i32 v77, v77
    v_cvt_f32_i32 v78, v78
    v_cvt_f32_i32 v79, v79
    v_cvt_f32_i32 v80, v80
    v_cvt_f32_i32 v81, v81
    v_cvt_f32_i32 v82, v82
    v_cvt_f32_i32 v83, v83
    v_cvt_f32_i32 v84, v84
    v_cvt_f32_i32 v85, v85
    s_barrier
    v_cvt_f32_i32 v86, v86
    v_cvt_f32_i32 v87, v87
    v_mul_f32 v104, v104, v96
    v_mul_f32 v105, v105, v97
    v_mul_f32 v106, v106, v98
    v_mul_f32 v107, v107, v99
    v_mul_f32 v108, v108, v100
    v_mul_f32 v109, v109, v101
    v_mul_f32 v110, v110, v102
    v_mul_f32 v111, v111, v103
    v_fma_f32 v56, v56, v96, -v104
    v_fma_f32 v57, v57, v96, -v104
    v_fma_f32 v58, v58, v96, -v104
    v_fma_f32 v59, v59, v96, -v104
    v_fma_f32 v60, v60, v97, -v105
    v_fma_f32 v61, v61, v97, -v105
    v_fma_f32 v62, v62, v97, -v105
    v_fma_f32 v63, v63, v97, -v105
    v_fma_f32 v64, v64, v98, -v106
    v_fma_f32 v65, v65, v98, -v106
    v_fma_f32 v66, v66, v98, -v106
    v_fma_f32 v67, v67, v98, -v106
    v_fma_f32 v68, v68, v99, -v107
    v_fma_f32 v69, v69, v99, -v107
    v_fma_f32 v70, v70, v99, -v107
    v_fma_f32 v71, v71, v99, -v107
    v_fma_f32 v72, v72, v100, -v108
    v_fma_f32 v73, v73, v100, -v108
    v_fma_f32 v74, v74, v100, -v108
    v_fma_f32 v75, v75, v100, -v108
    v_fma_f32 v76, v76, v101, -v109
    v_fma_f32 v77, v77, v101, -v109
    v_fma_f32 v78, v78, v101, -v109
    v_fma_f32 v79, v79, v101, -v109
    v_fma_f32 v80, v80, v102, -v110
    v_fma_f32 v81, v81, v102, -v110
    v_fma_f32 v82, v82, v102, -v110
    v_fma_f32 v83, v83, v102, -v110
    v_fma_f32 v84, v84, v103, -v111
    v_fma_f32 v85, v85, v103, -v111
    v_fma_f32 v86, v86, v103, -v111
    v_fma_f32 v87, v87, v103, -v111
    v_cvt_pk_bf16_f32 v128, v56, v60
    v_cvt_pk_bf16_f32 v129, v64, v68
    v_cvt_pk_bf16_f32 v130, v72, v76
    v_cvt_pk_bf16_f32 v131, v80, v84
    buffer_store_dwordx4 v[128:131], v8, s[24:27], s90 offen offset:0 sc0 sc1
    v_cvt_pk_bf16_f32 v132, v57, v61
    v_cvt_pk_bf16_f32 v133, v65, v69
    v_cvt_pk_bf16_f32 v134, v73, v77
    v_cvt_pk_bf16_f32 v135, v81, v85
    buffer_store_dwordx4 v[132:135], v8, s[24:27], s90 offen offset:1024 sc0 sc1
    v_cvt_pk_bf16_f32 v136, v58, v62
    v_cvt_pk_bf16_f32 v137, v66, v70
    v_cvt_pk_bf16_f32 v138, v74, v78
    v_cvt_pk_bf16_f32 v139, v82, v86
    buffer_store_dwordx4 v[136:139], v8, s[24:27], s90 offen offset:2048 sc0 sc1
    v_cvt_pk_bf16_f32 v140, v59, v63
    v_cvt_pk_bf16_f32 v141, v67, v71
    v_cvt_pk_bf16_f32 v142, v75, v79
    v_cvt_pk_bf16_f32 v143, v83, v87
    buffer_store_dwordx4 v[140:143], v8, s[24:27], s90 offen offset:3072 sc0 sc1
    s_add_u32 s90, s90, 0x20000
    s_barrier
    s_barrier
    s_barrier
    s_waitcnt vmcnt(0)
    s_add_u32 s85, s40, 8
    v_mov_b32 v10, s85
    v_mov_b32 v11, s84
    s_mov_b64 exec, 1
    buffer_store_dword v10, v11, s[72:75], 0 offen sc0 sc1
    s_mov_b64 exec, -1
    s_barrier
    s_barrier
    s_barrier
    s_barrier
    s_barrier
    s_barrier
    s_barrier
    s_barrier
    s_barrier
    s_barrier
    s_branch standalone__kv_cache_quant_pre_rope_vs_post_rope__prompt_kernel_hfin
standalone__kv_cache_quant_pre_rope_vs_post_rope__prompt_kernel_hfin:
    s_barrier
    s_cmp_lg_u32 s19, 0
    s_cbranch_scc1 standalone__kv_cache_quant_pre_rope_vs_post_rope__prompt_kernel_end
    v_mov_b32 v11, 131072
    ds_read_b32 v10, v11
    s_waitcnt lgkmcnt(0)
    v_readfirstlane_b32 s18, v10
    s_cmp_eq_u32 s18, 0
    s_cbranch_scc1 standalone__kv_cache_quant_pre_rope_vs_post_rope__prompt_kernel_end
    s_mov_b32 s19, 1
    s_barrier
    s_barrier
    s_barrier
    s_barrier
    s_barrier
    s_barrier
    s_barrier
    s_barrier
    s_barrier
    s_barrier
    s_barrier
    s_barrier
    s_barrier
    s_barrier
    s_barrier
    s_barrier
    s_barrier
    s_barrier
    s_barrier
    s_barrier
    s_barrier
    s_barrier
    s_barrier
    s_barrier
    s_barrier
    s_barrier
    s_barrier
    s_barrier
    s_barrier
    s_barrier
    s_barrier
    s_barrier
    s_barrier
    s_barrier
    s_branch standalone__kv_cache_quant_pre_rope_vs_post_rope__prompt_kernel_hfin
standalone__kv_cache_quant_pre_rope_vs_post_rope__prompt_kernel_loader:
    s_setprio 3
    v_lshlrev_b32 v5, 4, v2
    v_lshlrev_b32 v6, 2, v2
    s_add_u32 s4, s70, s42
    s_addc_u32 s5, s71, 0
    s_mov_b32 s6, 0x100
    s_mov_b32 s7, 0x20000
    s_add_u32 s8, s70, s42
    s_addc_u32 s9, s71, 0
    s_mov_b32 s10, s70
    s_mov_b32 s11, s71
standalone__kv_cache_quant_pre_rope_vs_post_rope__prompt_kernel_l_npoll:
    v_mov_b32 v12, s41
    global_load_dword v13, v12, s[68:69] sc1
    s_waitcnt vmcnt(0)
    v_readfirstlane_b32 s40, v13
    s_cmp_eq_u32 s40, 0
    s_cbranch_scc1 standalone__kv_cache_quant_pre_rope_vs_post_rope__prompt_kernel_l_npoll
    s_and_b32 s40, s40, 0xfffffff0
    s_barrier
    s_barrier
    s_mov_b32 s12, -1
    s_mov_b32 s13, 0xffff
standalone__kv_cache_quant_pre_rope_vs_post_rope__prompt_kernel_lmain:
    s_add_u32 s35, s40, 1
    s_mov_b32 s34, 32
standalone__kv_cache_quant_pre_rope_vs_post_rope__prompt_kernel_spoll:
    s_load_dwordx16 s[44:59], s[8:9], 0 glc
    s_load_dwordx16 s[60:75], s[8:9], 64 glc
    s_load_dwordx16 s[76:91], s[8:9], 128 glc
    s_waitcnt lgkmcnt(0)
    s_mov_b32 s16, 0
    s_sub_u32 s44, s44, s35
    s_max_u32 s16, s16, s44
    s_sub_u32 s45, s45, s35
    s_max_u32 s16, s16, s45
    s_sub_u32 s46, s46, s35
    s_max_u32 s16, s16, s46
    s_sub_u32 s47, s47, s35
    s_max_u32 s16, s16, s47
    s_sub_u32 s48, s48, s35
    s_max_u32 s16, s16, s48
    s_sub_u32 s49, s49, s35
    s_max_u32 s16, s16, s49
    s_sub_u32 s50, s50, s35
    s_max_u32 s16, s16, s50
    s_sub_u32 s51, s51, s35
    s_max_u32 s16, s16, s51
    s_sub_u32 s52, s52, s35
    s_max_u32 s16, s16, s52
    s_sub_u32 s53, s53, s35
    s_max_u32 s16, s16, s53
    s_sub_u32 s54, s54, s35
    s_max_u32 s16, s16, s54
    s_sub_u32 s55, s55, s35
    s_max_u32 s16, s16, s55
    s_sub_u32 s56, s56, s35
    s_max_u32 s16, s16, s56
    s_sub_u32 s57, s57, s35
    s_max_u32 s16, s16, s57
    s_sub_u32 s58, s58, s35
    s_max_u32 s16, s16, s58
    s_sub_u32 s59, s59, s35
    s_max_u32 s16, s16, s59
    s_sub_u32 s60, s60, s35
    s_max_u32 s16, s16, s60
    s_sub_u32 s61, s61, s35
    s_max_u32 s16, s16, s61
    s_sub_u32 s62, s62, s35
    s_max_u32 s16, s16, s62
    s_sub_u32 s63, s63, s35
    s_max_u32 s16, s16, s63
    s_sub_u32 s64, s64, s35
    s_max_u32 s16, s16, s64
    s_sub_u32 s65, s65, s35
    s_max_u32 s16, s16, s65
    s_sub_u32 s66, s66, s35
    s_max_u32 s16, s16, s66
    s_sub_u32 s67, s67, s35
    s_max_u32 s16, s16, s67
    s_sub_u32 s68, s68, s35
    s_max_u32 s16, s16, s68
    s_sub_u32 s69, s69, s35
    s_max_u32 s16, s16, s69
    s_sub_u32 s70, s70, s35
    s_max_u32 s16, s16, s70
    s_sub_u32 s71, s71, s35
    s_max_u32 s16, s16, s71
    s_sub_u32 s72, s72, s35
    s_max_u32 s16, s16, s72
    s_sub_u32 s73, s73, s35
    s_max_u32 s16, s16, s73
    s_sub_u32 s74, s74, s35
    s_max_u32 s16, s16, s74
    s_sub_u32 s75, s75, s35
    s_max_u32 s16, s16, s75
    s_sub_u32 s76, s76, s35
    s_max_u32 s16, s16, s76
    s_sub_u32 s77, s77, s35
    s_max_u32 s16, s16, s77
    s_sub_u32 s78, s78, s35
    s_max_u32 s16, s16, s78
    s_sub_u32 s79, s79, s35
    s_max_u32 s16, s16, s79
    s_sub_u32 s80, s80, s35
    s_max_u32 s16, s16, s80
    s_sub_u32 s81, s81, s35
    s_max_u32 s16, s16, s81
    s_sub_u32 s82, s82, s35
    s_max_u32 s16, s16, s82
    s_sub_u32 s83, s83, s35
    s_max_u32 s16, s16, s83
    s_sub_u32 s84, s84, s35
    s_max_u32 s16, s16, s84
    s_sub_u32 s85, s85, s35
    s_max_u32 s16, s16, s85
    s_sub_u32 s86, s86, s35
    s_max_u32 s16, s16, s86
    s_sub_u32 s87, s87, s35
    s_max_u32 s16, s16, s87
    s_sub_u32 s88, s88, s35
    s_max_u32 s16, s16, s88
    s_sub_u32 s89, s89, s35
    s_max_u32 s16, s16, s89
    s_sub_u32 s90, s90, s35
    s_max_u32 s16, s16, s90
    s_sub_u32 s91, s91, s35
    s_max_u32 s16, s16, s91
    s_cmp_lt_u32 s16, 15
    s_cbranch_scc1 standalone__kv_cache_quant_pre_rope_vs_post_rope__prompt_kernel_sok
    s_sub_u32 s34, s34, 1
    s_cmp_lg_u32 s34, 0
    s_cbranch_scc1 standalone__kv_cache_quant_pre_rope_vs_post_rope__prompt_kernel_spoll
standalone__kv_cache_quant_pre_rope_vs_post_rope__prompt_kernel_lchk0:
    buffer_load_dword v10, v6, s[4:7], 0 offen sc1
    s_waitcnt vmcnt(0)
standalone__kv_cache_quant_pre_rope_vs_post_rope__prompt_kernel_lchk0_t:
    v_subrev_u32 v11, s40, v10
    v_cmp_le_u32 vcc, 1, v11
    s_nop 3
    s_mov_b64 s[14:15], vcc
    v_cmp_gt_u32 vcc, 16, v11
    s_nop 3
    s_and_b64 s[14:15], s[14:15], vcc
    s_and_b64 s[14:15], s[14:15], s[12:13]
    s_cmp_eq_u64 s[14:15], s[12:13]
    s_cbranch_scc0 standalone__kv_cache_quant_pre_rope_vs_post_rope__prompt_kernel_lchk0
standalone__kv_cache_quant_pre_rope_vs_post_rope__prompt_kernel_sok:
    s_mov_b32 s31, -1
    s_mov_b32 s33, 0
    s_max_i32 s16, s31, 0
    s_min_i32 s16, s16, 31
    s_lshl_b32 s16, s16, 15
    s_add_i32 s17, s31, -1
    s_max_i32 s17, s17, 0
    s_min_i32 s17, s17, 31
    s_lshl_b32 s17, s17, 15
    s_add_i32 s34, s31, 1
    s_min_i32 s34, s34, 31
    s_lshl_b32 s34, s34, 15
    s_add_u32 s36, s16, 8192
    s_add_u32 s37, s17, 24576
    s_add_u32 s39, s16, 16384
    s_add_u32 m0, s33, 16384
    s_nop 0
    buffer_load_dwordx4 v5, s[24:27], s34 offen offset:0 sc1 lds
    buffer_load_dwordx4 v5, s[24:27], s34 offen offset:1024 sc1 lds
    buffer_load_dwordx4 v5, s[24:27], s34 offen offset:2048 sc1 lds
    buffer_load_dwordx4 v5, s[24:27], s34 offen offset:3072 sc1 lds
    s_add_u32 m0, s33, 20480
    s_add_u32 s34, s34, 4096
    buffer_load_dwordx4 v5, s[24:27], s34 offen offset:0 sc1 lds
    buffer_load_dwordx4 v5, s[24:27], s34 offen offset:1024 sc1 lds
    buffer_load_dwordx4 v5, s[24:27], s34 offen offset:2048 sc1 lds
    buffer_load_dwordx4 v5, s[24:27], s34 offen offset:3072 sc1 lds
    s_add_u32 s33, s33, 0x8000
    s_and_b32 s33, s33, 0x1ffff
    s_add_i32 s31, s31, 1
    s_max_i32 s16, s31, 0
    s_min_i32 s16, s16, 31
    s_lshl_b32 s16, s16, 15
    s_add_i32 s17, s31, -1
    s_max_i32 s17, s17, 0
    s_min_i32 s17, s17, 31
    s_lshl_b32 s17, s17, 15
    s_add_i32 s34, s31, 1
    s_min_i32 s34, s34, 31
    s_lshl_b32 s34, s34, 15
    s_add_u32 s36, s16, 8192
    s_add_u32 s37, s17, 24576
    s_add_u32 s39, s16, 16384
    s_add_u32 m0, s33, 0
    s_nop 0
    buffer_load_dwordx4 v5, s[24:27], s36 offen offset:0 sc1 lds
    buffer_load_dwordx4 v5, s[24:27], s36 offen offset:1024 sc1 lds
    buffer_load_dwordx4 v5, s[24:27], s36 offen offset:2048 sc1 lds
    buffer_load_dwordx4 v5, s[24:27], s36 offen offset:3072 sc1 lds
    s_add_u32 m0, s33, 4096
    s_add_u32 s36, s36, 4096
    buffer_load_dwordx4 v5, s[24:27], s36 offen offset:0 sc1 lds
    buffer_load_dwordx4 v5, s[24:27], s36 offen offset:1024 sc1 lds
    buffer_load_dwordx4 v5, s[24:27], s36 offen offset:2048 sc1 lds
    buffer_load_dwordx4 v5, s[24:27], s36 offen offset:3072 sc1 lds
    s_add_u32 m0, s33, 16384
    s_nop 0
    buffer_load_dwordx4 v5, s[24:27], s34 offen offset:0 sc1 lds
    buffer_load_dwordx4 v5, s[24:27], s34 offen offset:1024 sc1 lds
    buffer_load_dwordx4 v5, s[24:27], s34 offen offset:2048 sc1 lds
    buffer_load_dwordx4 v5, s[24:27], s34 offen offset:3072 sc1 lds
    s_add_u32 m0, s33, 20480
    s_add_u32 s34, s34, 4096
    buffer_load_dwordx4 v5, s[24:27], s34 offen offset:0 sc1 lds
    buffer_load_dwordx4 v5, s[24:27], s34 offen offset:1024 sc1 lds
    buffer_load_dwordx4 v5, s[24:27], s34 offen offset:2048 sc1 lds
    buffer_load_dwordx4 v5, s[24:27], s34 offen offset:3072 sc1 lds
    s_add_u32 m0, s33, 24576
    s_nop 0
    buffer_load_dwordx4 v5, s[24:27], s39 offen offset:0 sc1 lds
    buffer_load_dwordx4 v5, s[24:27], s39 offen offset:1024 sc1 lds
    buffer_load_dwordx4 v5, s[24:27], s39 offen offset:2048 sc1 lds
    buffer_load_dwordx4 v5, s[24:27], s39 offen offset:3072 sc1 lds
    s_add_u32 m0, s33, 28672
    s_add_u32 s39, s39, 4096
    buffer_load_dwordx4 v5, s[24:27], s39 offen offset:0 sc1 lds
    buffer_load_dwordx4 v5, s[24:27], s39 offen offset:1024 sc1 lds
    buffer_load_dwordx4 v5, s[24:27], s39 offen offset:2048 sc1 lds
    buffer_load_dwordx4 v5, s[24:27], s39 offen offset:3072 sc1 lds
    s_add_u32 s33, s33, 0x8000
    s_and_b32 s33, s33, 0x1ffff
    s_add_i32 s31, s31, 1
    s_waitcnt vmcnt(24)
    s_barrier
    s_max_i32 s16, s31, 0
    s_min_i32 s16, s16, 31
    s_lshl_b32 s16, s16, 15
    s_add_i32 s17, s31, -1
    s_max_i32 s17, s17, 0
    s_min_i32 s17, s17, 31
    s_lshl_b32 s17, s17, 15
    s_add_i32 s34, s31, 1
    s_min_i32 s34, s34, 31
    s_lshl_b32 s34, s34, 15
    s_add_u32 s36, s16, 8192
    s_add_u32 s37, s17, 24576
    s_add_u32 s39, s16, 16384
    s_add_u32 m0, s33, 0
    s_nop 0
    buffer_load_dwordx4 v5, s[24:27], s36 offen offset:0 sc1 lds
    buffer_load_dwordx4 v5, s[24:27], s36 offen offset:1024 sc1 lds
    buffer_load_dwordx4 v5, s[24:27], s36 offen offset:2048 sc1 lds
    buffer_load_dwordx4 v5, s[24:27], s36 offen offset:3072 sc1 lds
    s_add_u32 m0, s33, 4096
    s_add_u32 s36, s36, 4096
    buffer_load_dwordx4 v5, s[24:27], s36 offen offset:0 sc1 lds
    buffer_load_dwordx4 v5, s[24:27], s36 offen offset:1024 sc1 lds
    buffer_load_dwordx4 v5, s[24:27], s36 offen offset:2048 sc1 lds
    buffer_load_dwordx4 v5, s[24:27], s36 offen offset:3072 sc1 lds
    s_add_u32 m0, s33, 8192
    s_nop 0
    buffer_load_dwordx4 v5, s[24:27], s37 offen offset:0 sc1 lds
    buffer_load_dwordx4 v5, s[24:27], s37 offen offset:1024 sc1 lds
    buffer_load_dwordx4 v5, s[24:27], s37 offen offset:2048 sc1 lds
    buffer_load_dwordx4 v5, s[24:27], s37 offen offset:3072 sc1 lds
    s_add_u32 m0, s33, 12288
    s_add_u32 s37, s37, 4096
    buffer_load_dwordx4 v5, s[24:27], s37 offen offset:0 sc1 lds
    buffer_load_dwordx4 v5, s[24:27], s37 offen offset:1024 sc1 lds
    buffer_load_dwordx4 v5, s[24:27], s37 offen offset:2048 sc1 lds
    buffer_load_dwordx4 v5, s[24:27], s37 offen offset:3072 sc1 lds
    s_add_u32 m0, s33, 16384
    s_nop 0
    buffer_load_dwordx4 v5, s[24:27], s34 offen offset:0 sc1 lds
    buffer_load_dwordx4 v5, s[24:27], s34 offen offset:1024 sc1 lds
    buffer_load_dwordx4 v5, s[24:27], s34 offen offset:2048 sc1 lds
    buffer_load_dwordx4 v5, s[24:27], s34 offen offset:3072 sc1 lds
    s_add_u32 m0, s33, 20480
    s_add_u32 s34, s34, 4096
    buffer_load_dwordx4 v5, s[24:27], s34 offen offset:0 sc1 lds
    buffer_load_dwordx4 v5, s[24:27], s34 offen offset:1024 sc1 lds
    buffer_load_dwordx4 v5, s[24:27], s34 offen offset:2048 sc1 lds
    buffer_load_dwordx4 v5, s[24:27], s34 offen offset:3072 sc1 lds
    s_add_u32 m0, s33, 24576
    s_nop 0
    buffer_load_dwordx4 v5, s[24:27], s39 offen offset:0 sc1 lds
    buffer_load_dwordx4 v5, s[24:27], s39 offen offset:1024 sc1 lds
    buffer_load_dwordx4 v5, s[24:27], s39 offen offset:2048 sc1 lds
    buffer_load_dwordx4 v5, s[24:27], s39 offen offset:3072 sc1 lds
    s_add_u32 m0, s33, 28672
    s_add_u32 s39, s39, 4096
    buffer_load_dwordx4 v5, s[24:27], s39 offen offset:0 sc1 lds
    buffer_load_dwordx4 v5, s[24:27], s39 offen offset:1024 sc1 lds
    buffer_load_dwordx4 v5, s[24:27], s39 offen offset:2048 sc1 lds
    buffer_load_dwordx4 v5, s[24:27], s39 offen offset:3072 sc1 lds
    s_add_u32 s33, s33, 0x8000
    s_and_b32 s33, s33, 0x1ffff
    s_add_i32 s31, s31, 1
    s_setprio 0
standalone__kv_cache_quant_pre_rope_vs_post_rope__prompt_kernel_lloop:
    s_waitcnt vmcnt(32)
    s_barrier
    s_and_b32 s16, s31, 3
    s_cmp_eq_u32 s16, 3
    s_cbranch_scc0 standalone__kv_cache_quant_pre_rope_vs_post_rope__prompt_kernel_lnc
    s_add_u32 s35, s31, 5
    s_lshr_b32 s35, s35, 2
    s_min_u32 s35, s35, 8
    s_branch standalone__kv_cache_quant_pre_rope_vs_post_rope__prompt_kernel_lchk_t
standalone__kv_cache_quant_pre_rope_vs_post_rope__prompt_kernel_lchk:
    buffer_load_dword v10, v6, s[4:7], 0 offen sc1
    s_waitcnt vmcnt(0)
standalone__kv_cache_quant_pre_rope_vs_post_rope__prompt_kernel_lchk_t:
    v_subrev_u32 v11, s40, v10
    v_cmp_le_u32 vcc, s35, v11
    s_nop 3
    s_mov_b64 s[14:15], vcc
    v_cmp_gt_u32 vcc, 16, v11
    s_nop 3
    s_and_b64 s[14:15], s[14:15], vcc
    s_and_b64 s[14:15], s[14:15], s[12:13]
    s_cmp_eq_u64 s[14:15], s[12:13]
    s_cbranch_scc0 standalone__kv_cache_quant_pre_rope_vs_post_rope__prompt_kernel_lchk
standalone__kv_cache_quant_pre_rope_vs_post_rope__prompt_kernel_lnc:
    s_and_b32 s16, s31, 3
    s_cmp_eq_u32 s16, 2
    s_cbranch_scc0 standalone__kv_cache_quant_pre_rope_vs_post_rope__prompt_kernel_lnp
    buffer_load_dword v10, v6, s[4:7], 0 offen sc1
standalone__kv_cache_quant_pre_rope_vs_post_rope__prompt_kernel_lnp:
    s_max_i32 s16, s31, 0
    s_min_i32 s16, s16, 31
    s_lshl_b32 s16, s16, 15
    s_add_i32 s17, s31, -1
    s_max_i32 s17, s17, 0
    s_min_i32 s17, s17, 31
    s_lshl_b32 s17, s17, 15
    s_add_i32 s34, s31, 1
    s_min_i32 s34, s34, 31
    s_lshl_b32 s34, s34, 15
    s_add_u32 s36, s16, 8192
    s_add_u32 s37, s17, 24576
    s_add_u32 s39, s16, 16384
    s_add_u32 m0, s33, 0
    s_nop 0
    buffer_load_dwordx4 v5, s[24:27], s36 offen offset:0 sc1 lds
    buffer_load_dwordx4 v5, s[24:27], s36 offen offset:1024 sc1 lds
    buffer_load_dwordx4 v5, s[24:27], s36 offen offset:2048 sc1 lds
    buffer_load_dwordx4 v5, s[24:27], s36 offen offset:3072 sc1 lds
    s_add_u32 m0, s33, 4096
    s_add_u32 s36, s36, 4096
    buffer_load_dwordx4 v5, s[24:27], s36 offen offset:0 sc1 lds
    buffer_load_dwordx4 v5, s[24:27], s36 offen offset:1024 sc1 lds
    buffer_load_dwordx4 v5, s[24:27], s36 offen offset:2048 sc1 lds
    buffer_load_dwordx4 v5, s[24:27], s36 offen offset:3072 sc1 lds
    s_add_u32 m0, s33, 8192
    s_nop 0
    buffer_load_dwordx4 v5, s[24:27], s37 offen offset:0 sc1 lds
    buffer_load_dwordx4 v5, s[24:27], s37 offen offset:1024 sc1 lds
    buffer_load_dwordx4 v5, s[24:27], s37 offen offset:2048 sc1 lds
    buffer_load_dwordx4 v5, s[24:27], s37 offen offset:3072 sc1 lds
    s_add_u32 m0, s33, 12288
    s_add_u32 s37, s37, 4096
    buffer_load_dwordx4 v5, s[24:27], s37 offen offset:0 sc1 lds
    buffer_load_dwordx4 v5, s[24:27], s37 offen offset:1024 sc1 lds
    buffer_load_dwordx4 v5, s[24:27], s37 offen offset:2048 sc1 lds
    buffer_load_dwordx4 v5, s[24:27], s37 offen offset:3072 sc1 lds
    s_add_u32 m0, s33, 16384
    s_nop 0
    buffer_load_dwordx4 v5, s[24:27], s34 offen offset:0 sc1 lds
    buffer_load_dwordx4 v5, s[24:27], s34 offen offset:1024 sc1 lds
    buffer_load_dwordx4 v5, s[24:27], s34 offen offset:2048 sc1 lds
    buffer_load_dwordx4 v5, s[24:27], s34 offen offset:3072 sc1 lds
    s_add_u32 m0, s33, 20480
    s_add_u32 s34, s34, 4096
    buffer_load_dwordx4 v5, s[24:27], s34 offen offset:0 sc1 lds
    buffer_load_dwordx4 v5, s[24:27], s34 offen offset:1024 sc1 lds
    buffer_load_dwordx4 v5, s[24:27], s34 offen offset:2048 sc1 lds
    buffer_load_dwordx4 v5, s[24:27], s34 offen offset:3072 sc1 lds
    s_add_u32 m0, s33, 24576
    s_nop 0
    buffer_load_dwordx4 v5, s[24:27], s39 offen offset:0 sc1 lds
    buffer_load_dwordx4 v5, s[24:27], s39 offen offset:1024 sc1 lds
    buffer_load_dwordx4 v5, s[24:27], s39 offen offset:2048 sc1 lds
    buffer_load_dwordx4 v5, s[24:27], s39 offen offset:3072 sc1 lds
    s_add_u32 m0, s33, 28672
    s_add_u32 s39, s39, 4096
    buffer_load_dwordx4 v5, s[24:27], s39 offen offset:0 sc1 lds
    buffer_load_dwordx4 v5, s[24:27], s39 offen offset:1024 sc1 lds
    buffer_load_dwordx4 v5, s[24:27], s39 offen offset:2048 sc1 lds
    buffer_load_dwordx4 v5, s[24:27], s39 offen offset:3072 sc1 lds
    s_add_u32 s33, s33, 0x8000
    s_and_b32 s33, s33, 0x1ffff
    s_add_i32 s31, s31, 1
    s_cmp_le_i32 s31, 32
    s_cbranch_scc1 standalone__kv_cache_quant_pre_rope_vs_post_rope__prompt_kernel_lloop
    s_waitcnt vmcnt(32)
    s_barrier
    s_waitcnt vmcnt(0)
    s_barrier
    s_barrier
    s_cmp_lg_u32 s19, 0
    s_cbranch_scc1 standalone__kv_cache_quant_pre_rope_vs_post_rope__prompt_kernel_end
    v_mov_b32 v11, 131072
    ds_read_b32 v10, v11
    s_waitcnt lgkmcnt(0)
    v_readfirstlane_b32 s18, v10
    s_mov_b32 s19, 1
    s_cmp_lg_u32 s18, 0
    s_cbranch_scc1 standalone__kv_cache_quant_pre_rope_vs_post_rope__prompt_kernel_lmain
standalone__kv_cache_quant_pre_rope_vs_post_rope__prompt_kernel_end:
    s_endpgm
.section .rodata,"a"
.p2align 6
.amdhsa_kernel standalone__kv_cache_quant_pre_rope_vs_post_rope__prompt_kernel
  .amdhsa_next_free_vgpr 208
  .amdhsa_next_free_sgpr 100
  .amdhsa_accum_offset 208
  .amdhsa_group_segment_fixed_size 0
  .amdhsa_kernarg_size 112
  .amdhsa_user_sgpr_count 2
  .amdhsa_user_sgpr_kernarg_segment_ptr 1
  .amdhsa_system_sgpr_workgroup_id_x 1
.end_amdhsa_kernel
```
